```python
import torch

def _softmax(x, axis=-1):
    return torch.softmax(x, dim=axis)
def _gelu(x):
    return torch.nn.functional.gelu(x, approximate="tanh")
def _silu(x):
    return torch.nn.functional.silu(x)
def _sigmoid(x):
    return torch.sigmoid(x)
def _layernorm(x, axis=-1, eps=1e-5):
    m = x.mean(dim=axis, keepdim=True)
    v = x.var(dim=axis, keepdim=True, unbiased=False)
    return (x - m) / torch.sqrt(v + eps)
def _scatter_add(tgt, idx, src, axis=0):
    return tgt.clone().index_add_(axis, idx, src)
def _segment_sum(src, seg, n):
    out = torch.zeros((n,) + src.shape[1:], dtype=src.dtype)
    return out.index_add_(0, seg, src)
def _pad(x, pw):
    flat = tuple(v for pair in reversed(pw) for v in pair)
    return torch.nn.functional.pad(x, flat)

kernel_name = 'standalone__kv_cache_quant_int4_int2_kv_with_per_channel_or_per_token_scales__decode'

def setup_inputs():

    _w = (lambda a: (lambda t: t.to(torch.bfloat16) if t.is_floating_point() else t)(torch.as_tensor(a)))
    B = 8
    Sq = 1
    Skv = 4096
    Hq = 16
    Hkv = 8
    Dh = 256
    bits = 3
    G = 128
    if G <= 0 or G >= Skv:
        G = max(1, Skv // 2)
    Skv = (Skv // G) * G
    ngk = Skv // G
    qmax = (1 << bits) - 1
    return {
        "q": _w((lambda *s: torch.randn(*s, dtype=torch.bfloat16) * 3.2)(B, Hq, Sq, Dh)),
        "qk": _w(torch.randint(0, qmax + 1, (B, Hkv, Skv, Dh)).to(torch.int32)),
        "qv": _w(torch.randint(0, qmax + 1, (B, Hkv, Skv, Dh)).to(torch.int32)),
        "k_scales": _w(torch.abs((lambda *s: torch.randn(*s, dtype=torch.bfloat16) * 3.2)(B, Hkv, ngk, Dh)) * 0.05 + 0.02),
        "k_zeros": _w((lambda *s: torch.randn(*s, dtype=torch.bfloat16) * 3.2)(B, Hkv, ngk, Dh) + float(qmax) / 2.0),
        "v_scales": _w(torch.abs((lambda *s: torch.randn(*s, dtype=torch.bfloat16) * 0.05)(B, Hkv, Skv, 1)) * 0.05 + 0.02),
        "v_zeros": _w((lambda *s: torch.randn(*s, dtype=torch.bfloat16) * 0.05)(B, Hkv, Skv, 1) + float(qmax) / 2.0),
    }

def reference(q, qk, qv, k_scales, k_zeros, v_scales, v_zeros):
    B, Hq, Sq, Dh = q.shape
    Hkv, Skv = qk.shape[1], qk.shape[2]
    ngk = k_scales.shape[2]
    G = Skv // ngk
    ks = (lambda x, n, axis: torch.repeat_interleave(x, n, dim=axis))(k_scales, G, axis=2)
    kz = (lambda x, n, axis: torch.repeat_interleave(x, n, dim=axis))(k_zeros, G, axis=2)
    k = ((lambda x, dt: x.to(dt))(qk, q.dtype) - kz) * ks
    v = ((lambda x, dt: x.to(dt))(qv, q.dtype) - v_zeros) * v_scales
    rep = Hq // Hkv
    if rep > 1:
        k = (lambda x, n, axis: torch.repeat_interleave(x, n, dim=axis))(k, rep, axis=1)
        v = (lambda x, n, axis: torch.repeat_interleave(x, n, dim=axis))(v, rep, axis=1)
    scale = float(Dh) ** -0.5
    logits = torch.einsum("bhqd,bhkd->bhqk", q, k) * scale
    p = _softmax(logits, axis=-1)
    o = torch.einsum("bhqk,bhkd->bhqd", p, v)
    return o
```

```asm
; @launch grid=(256,1,1) block=(512,1,1) lds=16512
.amdgcn_target "amdgcn-amd-amdhsa--gfx950"
.text
.globl standalone__kv_cache_quant_int4_int2_kv_with_per_channel_or_per_token_scales__decode_kernel
.p2align 8
.type standalone__kv_cache_quant_int4_int2_kv_with_per_channel_or_per_token_scales__decode_kernel,@function
standalone__kv_cache_quant_int4_int2_kv_with_per_channel_or_per_token_scales__decode_kernel:
    s_cmp_ge_u32 s2, 256
    s_cbranch_scc1 L_part_end
    s_load_dwordx16 s[4:19], s[0:1], 0
    s_load_dwordx4 s[20:23], s[0:1], 64
    v_and_b32 v2, 63, v0
    v_lshrrev_b32 v38, 6, v0
    v_lshlrev_b32 v1, 4, v2
    v_readfirstlane_b32 s38, v38
    v_lshlrev_b32 v7, 3, v2
    s_lshr_b32 s36, s2, 2
    s_lshl_b32 s58, s2, 10
    s_mov_b32 s26, 0x10000000
    s_mov_b32 s27, 0x00020000
    s_lshl_b32 s41, s38, 2
    s_add_u32 s39, s58, s41
    s_lshl_b32 s51, s39, 10
    s_lshl_b32 s59, s2, 12
    s_mov_b32 s62, 1048576
    s_mov_b32 s63, 0x00020000
    s_mov_b32 s66, 1048576
    s_mov_b32 s67, 0x00020000
    s_waitcnt lgkmcnt(0)
    s_mov_b32 s24, s6
    s_and_b32 s25, s7, 0xffff
    s_mov_b32 s60, s10
    s_and_b32 s61, s11, 0xffff
    s_mov_b32 s64, s12
    s_and_b32 s65, s13, 0xffff
    s_mov_b32 s32, s4
    s_and_b32 s33, s5, 0xffff
    s_mov_b32 s34, 65536
    s_mov_b32 s35, 0x00020000
    s_lshl_b32 s41, s36, 10
    buffer_load_dwordx2 v[32:33], v7, s[32:35], s41 offen
    buffer_load_dwordx2 v[34:35], v7, s[32:35], s41 offen offset:512
    buffer_load_dwordx2 v[40:41], v7, s[60:63], s59 offen
    buffer_load_dwordx2 v[42:43], v7, s[64:67], s59 offen
    s_add_u32 s59, s59, 512
    buffer_load_dwordx4 v[80:83], v1, s[24:27], s51 offen offset:0 nt
    buffer_load_dwordx4 v[84:87], v1, s[24:27], s51 offen offset:1024 nt
    buffer_load_dwordx4 v[88:91], v1, s[24:27], s51 offen offset:2048 nt
    s_mov_b32 s28, s8
    s_and_b32 s29, s9, 0xffff
    s_mov_b32 s30, 0x10000000
    s_mov_b32 s31, 0x00020000
    s_mov_b32 s52, s22
    s_and_b32 s53, s23, 0xffff
    s_mov_b32 s54, 0x40000000
    s_mov_b32 s55, 0x00020000
    s_mov_b32 s50, 0x3db8aa3b
    s_lshl_b32 s40, s38, 11
    v_lshrrev_b32 v8, 5, v2
    v_lshlrev_b32 v5, 9, v8
    v_bfe_u32 v8, v2, 4, 1
    v_lshl_add_u32 v5, v8, 2, v5
    v_bfe_u32 v8, v2, 3, 1
    v_lshl_add_u32 v5, v8, 3, v5
    v_bfe_u32 v8, v2, 2, 1
    v_lshl_add_u32 v5, v8, 4, v5
    v_add_u32 v5, s40, v5
    v_and_b32 v8, 15, v2
    v_lshrrev_b32 v9, 1, v8
    v_lshrrev_b32 v10, 4, v2
    v_cmp_eq_u32 vcc, v9, v10
    v_and_b32 v11, 1, v2
    v_lshlrev_b32 v11, 8, v11
    v_add_u32 v11, 1024, v11
    v_mov_b32 v12, 1536
    v_cndmask_b32 v6, v12, v11, vcc
    v_add_u32 v6, s40, v6
    v_lshlrev_b32 v8, 2, v2
    v_add_u32 v8, s40, v8
    v_mov_b32 v9, 0
    ds_write_b32 v8, v9 offset:1536
    v_mov_b32 v60, 0
    v_mov_b32 v61, 0
    v_mov_b32 v62, 0
    v_mov_b32 v63, 0
    v_mov_b32 v64, 0
    v_mov_b32 v65, 0
    v_mov_b32 v66, 0
    v_mov_b32 v67, 0
    v_mov_b32 v68, 0
    v_mov_b32 v69, 0
    v_mov_b32 v70, 0
    v_mov_b32 v71, 0
    v_mov_b32 v72, 0
    v_mov_b32 v73, 0
    v_mov_b32 v74, 0
    v_mov_b32 v75, 0
    s_mov_b32 s42, 7
    s_nop 3
L_kloop:
    s_waitcnt vmcnt(3)
    v_lshlrev_b32 v28, 16, v40
    v_and_b32 v29, 0xffff0000, v40
    v_lshlrev_b32 v30, 16, v41
    v_and_b32 v31, 0xffff0000, v41
    v_lshlrev_b32 v24, 16, v42
    v_and_b32 v25, 0xffff0000, v42
    v_lshlrev_b32 v26, 16, v43
    v_and_b32 v27, 0xffff0000, v43
    buffer_load_dwordx2 v[40:41], v7, s[60:63], s59 offen
    buffer_load_dwordx2 v[42:43], v7, s[64:67], s59 offen
    s_add_u32 s59, s59, 512
    s_waitcnt vmcnt(4)
    buffer_load_dwordx4 v[92:95], v1, s[24:27], s51 offen offset:3072 nt
    s_add_u32 s51, s51, 32768
    v_cvt_f32_i32 v8, v80
    v_cvt_f32_i32 v9, v81
    v_cvt_f32_i32 v10, v82
    v_cvt_f32_i32 v11, v83
    v_cvt_pk_bf16_f32 v8, 0, v8
    v_cvt_pk_bf16_f32 v9, 0, v9
    v_cvt_pk_bf16_f32 v10, 0, v10
    v_cvt_pk_bf16_f32 v11, 0, v11
    v_sub_f32 v8, v8, v24
    v_sub_f32 v9, v9, v25
    v_sub_f32 v10, v10, v26
    v_sub_f32 v11, v11, v27
    v_cvt_pk_bf16_f32 v8, 0, v8
    v_cvt_pk_bf16_f32 v9, 0, v9
    v_cvt_pk_bf16_f32 v10, 0, v10
    v_cvt_pk_bf16_f32 v11, 0, v11
    v_mul_f32 v8, v8, v28
    v_mul_f32 v9, v9, v29
    v_mul_f32 v10, v10, v30
    v_mul_f32 v11, v11, v31
    v_cvt_pk_bf16_f32 v16, v8, v9
    v_cvt_pk_bf16_f32 v17, v10, v11
    v_dot2_f32_bf16 v44, v16, v32, 0
    v_dot2_f32_bf16 v45, v16, v34, 0
    v_dot2_f32_bf16 v44, v17, v33, v44
    v_dot2_f32_bf16 v45, v17, v35, v45
    s_waitcnt vmcnt(4)
    buffer_load_dwordx4 v[80:83], v1, s[24:27], s51 offen offset:0 nt
    v_cvt_f32_i32 v12, v84
    v_cvt_f32_i32 v13, v85
    v_cvt_f32_i32 v14, v86
    v_cvt_f32_i32 v15, v87
    v_cvt_pk_bf16_f32 v12, 0, v12
    v_cvt_pk_bf16_f32 v13, 0, v13
    v_cvt_pk_bf16_f32 v14, 0, v14
    v_cvt_pk_bf16_f32 v15, 0, v15
    v_sub_f32 v12, v12, v24
    v_sub_f32 v13, v13, v25
    v_sub_f32 v14, v14, v26
    v_sub_f32 v15, v15, v27
    v_cvt_pk_bf16_f32 v12, 0, v12
    v_cvt_pk_bf16_f32 v13, 0, v13
    v_cvt_pk_bf16_f32 v14, 0, v14
    v_cvt_pk_bf16_f32 v15, 0, v15
    v_mul_f32 v12, v12, v28
    v_mul_f32 v13, v13, v29
    v_mul_f32 v14, v14, v30
    v_mul_f32 v15, v15, v31
    v_cvt_pk_bf16_f32 v18, v12, v13
    v_cvt_pk_bf16_f32 v19, v14, v15
    v_dot2_f32_bf16 v46, v18, v32, 0
    v_dot2_f32_bf16 v47, v18, v34, 0
    v_dot2_f32_bf16 v46, v19, v33, v46
    v_dot2_f32_bf16 v47, v19, v35, v47
    s_waitcnt vmcnt(4)
    buffer_load_dwordx4 v[84:87], v1, s[24:27], s51 offen offset:1024 nt
    v_cvt_f32_i32 v8, v88
    v_cvt_f32_i32 v9, v89
    v_cvt_f32_i32 v10, v90
    v_cvt_f32_i32 v11, v91
    v_cvt_pk_bf16_f32 v8, 0, v8
    v_cvt_pk_bf16_f32 v9, 0, v9
    v_cvt_pk_bf16_f32 v10, 0, v10
    v_cvt_pk_bf16_f32 v11, 0, v11
    v_sub_f32 v8, v8, v24
    v_sub_f32 v9, v9, v25
    v_sub_f32 v10, v10, v26
    v_sub_f32 v11, v11, v27
    v_cvt_pk_bf16_f32 v8, 0, v8
    v_cvt_pk_bf16_f32 v9, 0, v9
    v_cvt_pk_bf16_f32 v10, 0, v10
    v_cvt_pk_bf16_f32 v11, 0, v11
    v_mul_f32 v8, v8, v28
    v_mul_f32 v9, v9, v29
    v_mul_f32 v10, v10, v30
    v_mul_f32 v11, v11, v31
    v_cvt_pk_bf16_f32 v16, v8, v9
    v_cvt_pk_bf16_f32 v17, v10, v11
    v_dot2_f32_bf16 v48, v16, v32, 0
    v_dot2_f32_bf16 v49, v16, v34, 0
    v_dot2_f32_bf16 v48, v17, v33, v48
    v_dot2_f32_bf16 v49, v17, v35, v49
    s_waitcnt vmcnt(2)
    buffer_load_dwordx4 v[88:91], v1, s[24:27], s51 offen offset:2048 nt
    v_cvt_f32_i32 v12, v92
    v_cvt_f32_i32 v13, v93
    v_cvt_f32_i32 v14, v94
    v_cvt_f32_i32 v15, v95
    v_cvt_pk_bf16_f32 v12, 0, v12
    v_cvt_pk_bf16_f32 v13, 0, v13
    v_cvt_pk_bf16_f32 v14, 0, v14
    v_cvt_pk_bf16_f32 v15, 0, v15
    v_sub_f32 v12, v12, v24
    v_sub_f32 v13, v13, v25
    v_sub_f32 v14, v14, v26
    v_sub_f32 v15, v15, v27
    v_cvt_pk_bf16_f32 v12, 0, v12
    v_cvt_pk_bf16_f32 v13, 0, v13
    v_cvt_pk_bf16_f32 v14, 0, v14
    v_cvt_pk_bf16_f32 v15, 0, v15
    v_mul_f32 v12, v12, v28
    v_mul_f32 v13, v13, v29
    v_mul_f32 v14, v14, v30
    v_mul_f32 v15, v15, v31
    v_cvt_pk_bf16_f32 v18, v12, v13
    v_cvt_pk_bf16_f32 v19, v14, v15
    v_dot2_f32_bf16 v50, v18, v32, 0
    v_dot2_f32_bf16 v51, v18, v34, 0
    v_dot2_f32_bf16 v50, v19, v33, v50
    v_dot2_f32_bf16 v51, v19, v35, v51
    s_waitcnt vmcnt(2)
    buffer_load_dwordx4 v[92:95], v1, s[24:27], s51 offen offset:3072 nt
    s_add_u32 s51, s51, 32768
    v_cvt_f32_i32 v8, v80
    v_cvt_f32_i32 v9, v81
    v_cvt_f32_i32 v10, v82
    v_cvt_f32_i32 v11, v83
    v_cvt_pk_bf16_f32 v8, 0, v8
    v_cvt_pk_bf16_f32 v9, 0, v9
    v_cvt_pk_bf16_f32 v10, 0, v10
    v_cvt_pk_bf16_f32 v11, 0, v11
    v_sub_f32 v8, v8, v24
    v_sub_f32 v9, v9, v25
    v_sub_f32 v10, v10, v26
    v_sub_f32 v11, v11, v27
    v_cvt_pk_bf16_f32 v8, 0, v8
    v_cvt_pk_bf16_f32 v9, 0, v9
    v_cvt_pk_bf16_f32 v10, 0, v10
    v_cvt_pk_bf16_f32 v11, 0, v11
    v_mul_f32 v8, v8, v28
    v_mul_f32 v9, v9, v29
    v_mul_f32 v10, v10, v30
    v_mul_f32 v11, v11, v31
    v_cvt_pk_bf16_f32 v16, v8, v9
    v_cvt_pk_bf16_f32 v17, v10, v11
    v_dot2_f32_bf16 v52, v16, v32, 0
    v_dot2_f32_bf16 v53, v16, v34, 0
    v_dot2_f32_bf16 v52, v17, v33, v52
    v_dot2_f32_bf16 v53, v17, v35, v53
    s_waitcnt vmcnt(2)
    buffer_load_dwordx4 v[80:83], v1, s[24:27], s51 offen offset:0 nt
    v_cvt_f32_i32 v12, v84
    v_cvt_f32_i32 v13, v85
    v_cvt_f32_i32 v14, v86
    v_cvt_f32_i32 v15, v87
    v_cvt_pk_bf16_f32 v12, 0, v12
    v_cvt_pk_bf16_f32 v13, 0, v13
    v_cvt_pk_bf16_f32 v14, 0, v14
    v_cvt_pk_bf16_f32 v15, 0, v15
    v_sub_f32 v12, v12, v24
    v_sub_f32 v13, v13, v25
    v_sub_f32 v14, v14, v26
    v_sub_f32 v15, v15, v27
    v_cvt_pk_bf16_f32 v12, 0, v12
    v_cvt_pk_bf16_f32 v13, 0, v13
    v_cvt_pk_bf16_f32 v14, 0, v14
    v_cvt_pk_bf16_f32 v15, 0, v15
    v_mul_f32 v12, v12, v28
    v_mul_f32 v13, v13, v29
    v_mul_f32 v14, v14, v30
    v_mul_f32 v15, v15, v31
    v_cvt_pk_bf16_f32 v18, v12, v13
    v_cvt_pk_bf16_f32 v19, v14, v15
    v_dot2_f32_bf16 v54, v18, v32, 0
    v_dot2_f32_bf16 v55, v18, v34, 0
    v_dot2_f32_bf16 v54, v19, v33, v54
    v_dot2_f32_bf16 v55, v19, v35, v55
    s_waitcnt vmcnt(2)
    buffer_load_dwordx4 v[84:87], v1, s[24:27], s51 offen offset:1024 nt
    v_cvt_f32_i32 v8, v88
    v_cvt_f32_i32 v9, v89
    v_cvt_f32_i32 v10, v90
    v_cvt_f32_i32 v11, v91
    v_cvt_pk_bf16_f32 v8, 0, v8
    v_cvt_pk_bf16_f32 v9, 0, v9
    v_cvt_pk_bf16_f32 v10, 0, v10
    v_cvt_pk_bf16_f32 v11, 0, v11
    v_sub_f32 v8, v8, v24
    v_sub_f32 v9, v9, v25
    v_sub_f32 v10, v10, v26
    v_sub_f32 v11, v11, v27
    v_cvt_pk_bf16_f32 v8, 0, v8
    v_cvt_pk_bf16_f32 v9, 0, v9
    v_cvt_pk_bf16_f32 v10, 0, v10
    v_cvt_pk_bf16_f32 v11, 0, v11
    v_mul_f32 v8, v8, v28
    v_mul_f32 v9, v9, v29
    v_mul_f32 v10, v10, v30
    v_mul_f32 v11, v11, v31
    v_cvt_pk_bf16_f32 v16, v8, v9
    v_cvt_pk_bf16_f32 v17, v10, v11
    v_dot2_f32_bf16 v56, v16, v32, 0
    v_dot2_f32_bf16 v57, v16, v34, 0
    v_dot2_f32_bf16 v56, v17, v33, v56
    v_dot2_f32_bf16 v57, v17, v35, v57
    s_waitcnt vmcnt(2)
    buffer_load_dwordx4 v[88:91], v1, s[24:27], s51 offen offset:2048 nt
    v_cvt_f32_i32 v12, v92
    v_cvt_f32_i32 v13, v93
    v_cvt_f32_i32 v14, v94
    v_cvt_f32_i32 v15, v95
    v_cvt_pk_bf16_f32 v12, 0, v12
    v_cvt_pk_bf16_f32 v13, 0, v13
    v_cvt_pk_bf16_f32 v14, 0, v14
    v_cvt_pk_bf16_f32 v15, 0, v15
    v_sub_f32 v12, v12, v24
    v_sub_f32 v13, v13, v25
    v_sub_f32 v14, v14, v26
    v_sub_f32 v15, v15, v27
    v_cvt_pk_bf16_f32 v12, 0, v12
    v_cvt_pk_bf16_f32 v13, 0, v13
    v_cvt_pk_bf16_f32 v14, 0, v14
    v_cvt_pk_bf16_f32 v15, 0, v15
    v_mul_f32 v12, v12, v28
    v_mul_f32 v13, v13, v29
    v_mul_f32 v14, v14, v30
    v_mul_f32 v15, v15, v31
    v_cvt_pk_bf16_f32 v18, v12, v13
    v_cvt_pk_bf16_f32 v19, v14, v15
    v_dot2_f32_bf16 v58, v18, v32, 0
    v_dot2_f32_bf16 v59, v18, v34, 0
    v_dot2_f32_bf16 v58, v19, v33, v58
    v_dot2_f32_bf16 v59, v19, v35, v59
    v_permlane32_swap_b32 v44, v45
    v_permlane32_swap_b32 v46, v47
    v_permlane32_swap_b32 v48, v49
    v_permlane32_swap_b32 v50, v51
    v_permlane32_swap_b32 v52, v53
    v_permlane32_swap_b32 v54, v55
    v_permlane32_swap_b32 v56, v57
    v_permlane32_swap_b32 v58, v59
    v_add_f32 v44, v44, v45
    v_add_f32 v46, v46, v47
    v_add_f32 v48, v48, v49
    v_add_f32 v50, v50, v51
    v_add_f32 v52, v52, v53
    v_add_f32 v54, v54, v55
    v_add_f32 v56, v56, v57
    v_add_f32 v58, v58, v59
    v_permlane16_swap_b32 v44, v46
    v_permlane16_swap_b32 v48, v50
    v_permlane16_swap_b32 v52, v54
    v_permlane16_swap_b32 v56, v58
    v_add_f32 v44, v44, v46
    v_add_f32 v48, v48, v50
    v_add_f32 v52, v52, v54
    v_add_f32 v56, v56, v58
    v_add_f32_dpp v44, v44, v44 row_ror:8 row_mask:0xf bank_mask:0x3
    v_add_f32_dpp v44, v48, v48 row_ror:8 row_mask:0xf bank_mask:0xc
    v_add_f32_dpp v52, v52, v52 row_ror:8 row_mask:0xf bank_mask:0x3
    v_add_f32_dpp v52, v56, v56 row_ror:8 row_mask:0xf bank_mask:0xc
    v_add_f32_dpp v44, v44, v44 row_shl:4 row_mask:0xf bank_mask:0x5
    s_nop 0
    v_add_f32_dpp v44, v52, v52 row_shr:4 row_mask:0xf bank_mask:0xa
    s_nop 1
    v_add_f32_dpp v44, v44, v44 quad_perm:[1,0,3,2] row_mask:0xf bank_mask:0xf
    s_nop 1
    v_add_f32_dpp v44, v44, v44 quad_perm:[2,3,0,1] row_mask:0xf bank_mask:0xf
    ds_write_b32 v5, v44 offset:0
    s_waitcnt vmcnt(2)
    buffer_load_dwordx4 v[92:95], v1, s[24:27], s51 offen offset:3072 nt
    s_add_u32 s51, s51, 32768
    v_cvt_f32_i32 v8, v80
    v_cvt_f32_i32 v9, v81
    v_cvt_f32_i32 v10, v82
    v_cvt_f32_i32 v11, v83
    v_cvt_pk_bf16_f32 v8, 0, v8
    v_cvt_pk_bf16_f32 v9, 0, v9
    v_cvt_pk_bf16_f32 v10, 0, v10
    v_cvt_pk_bf16_f32 v11, 0, v11
    v_sub_f32 v8, v8, v24
    v_sub_f32 v9, v9, v25
    v_sub_f32 v10, v10, v26
    v_sub_f32 v11, v11, v27
    v_cvt_pk_bf16_f32 v8, 0, v8
    v_cvt_pk_bf16_f32 v9, 0, v9
    v_cvt_pk_bf16_f32 v10, 0, v10
    v_cvt_pk_bf16_f32 v11, 0, v11
    v_mul_f32 v8, v8, v28
    v_mul_f32 v9, v9, v29
    v_mul_f32 v10, v10, v30
    v_mul_f32 v11, v11, v31
    v_cvt_pk_bf16_f32 v16, v8, v9
    v_cvt_pk_bf16_f32 v17, v10, v11
    v_dot2_f32_bf16 v44, v16, v32, 0
    v_dot2_f32_bf16 v45, v16, v34, 0
    v_dot2_f32_bf16 v44, v17, v33, v44
    v_dot2_f32_bf16 v45, v17, v35, v45
    s_waitcnt vmcnt(2)
    buffer_load_dwordx4 v[80:83], v1, s[24:27], s51 offen offset:0 nt
    v_cvt_f32_i32 v12, v84
    v_cvt_f32_i32 v13, v85
    v_cvt_f32_i32 v14, v86
    v_cvt_f32_i32 v15, v87
    v_cvt_pk_bf16_f32 v12, 0, v12
    v_cvt_pk_bf16_f32 v13, 0, v13
    v_cvt_pk_bf16_f32 v14, 0, v14
    v_cvt_pk_bf16_f32 v15, 0, v15
    v_sub_f32 v12, v12, v24
    v_sub_f32 v13, v13, v25
    v_sub_f32 v14, v14, v26
    v_sub_f32 v15, v15, v27
    v_cvt_pk_bf16_f32 v12, 0, v12
    v_cvt_pk_bf16_f32 v13, 0, v13
    v_cvt_pk_bf16_f32 v14, 0, v14
    v_cvt_pk_bf16_f32 v15, 0, v15
    v_mul_f32 v12, v12, v28
    v_mul_f32 v13, v13, v29
    v_mul_f32 v14, v14, v30
    v_mul_f32 v15, v15, v31
    v_cvt_pk_bf16_f32 v18, v12, v13
    v_cvt_pk_bf16_f32 v19, v14, v15
    v_dot2_f32_bf16 v46, v18, v32, 0
    v_dot2_f32_bf16 v47, v18, v34, 0
    v_dot2_f32_bf16 v46, v19, v33, v46
    v_dot2_f32_bf16 v47, v19, v35, v47
    s_waitcnt vmcnt(2)
    buffer_load_dwordx4 v[84:87], v1, s[24:27], s51 offen offset:1024 nt
    v_cvt_f32_i32 v8, v88
    v_cvt_f32_i32 v9, v89
    v_cvt_f32_i32 v10, v90
    v_cvt_f32_i32 v11, v91
    v_cvt_pk_bf16_f32 v8, 0, v8
    v_cvt_pk_bf16_f32 v9, 0, v9
    v_cvt_pk_bf16_f32 v10, 0, v10
    v_cvt_pk_bf16_f32 v11, 0, v11
    v_sub_f32 v8, v8, v24
    v_sub_f32 v9, v9, v25
    v_sub_f32 v10, v10, v26
    v_sub_f32 v11, v11, v27
    v_cvt_pk_bf16_f32 v8, 0, v8
    v_cvt_pk_bf16_f32 v9, 0, v9
    v_cvt_pk_bf16_f32 v10, 0, v10
    v_cvt_pk_bf16_f32 v11, 0, v11
    v_mul_f32 v8, v8, v28
    v_mul_f32 v9, v9, v29
    v_mul_f32 v10, v10, v30
    v_mul_f32 v11, v11, v31
    v_cvt_pk_bf16_f32 v16, v8, v9
    v_cvt_pk_bf16_f32 v17, v10, v11
    v_dot2_f32_bf16 v48, v16, v32, 0
    v_dot2_f32_bf16 v49, v16, v34, 0
    v_dot2_f32_bf16 v48, v17, v33, v48
    v_dot2_f32_bf16 v49, v17, v35, v49
    s_waitcnt vmcnt(2)
    buffer_load_dwordx4 v[88:91], v1, s[24:27], s51 offen offset:2048 nt
    v_cvt_f32_i32 v12, v92
    v_cvt_f32_i32 v13, v93
    v_cvt_f32_i32 v14, v94
    v_cvt_f32_i32 v15, v95
    v_cvt_pk_bf16_f32 v12, 0, v12
    v_cvt_pk_bf16_f32 v13, 0, v13
    v_cvt_pk_bf16_f32 v14, 0, v14
    v_cvt_pk_bf16_f32 v15, 0, v15
    v_sub_f32 v12, v12, v24
    v_sub_f32 v13, v13, v25
    v_sub_f32 v14, v14, v26
    v_sub_f32 v15, v15, v27
    v_cvt_pk_bf16_f32 v12, 0, v12
    v_cvt_pk_bf16_f32 v13, 0, v13
    v_cvt_pk_bf16_f32 v14, 0, v14
    v_cvt_pk_bf16_f32 v15, 0, v15
    v_mul_f32 v12, v12, v28
    v_mul_f32 v13, v13, v29
    v_mul_f32 v14, v14, v30
    v_mul_f32 v15, v15, v31
    v_cvt_pk_bf16_f32 v18, v12, v13
    v_cvt_pk_bf16_f32 v19, v14, v15
    v_dot2_f32_bf16 v50, v18, v32, 0
    v_dot2_f32_bf16 v51, v18, v34, 0
    v_dot2_f32_bf16 v50, v19, v33, v50
    v_dot2_f32_bf16 v51, v19, v35, v51
    s_waitcnt vmcnt(2)
    buffer_load_dwordx4 v[92:95], v1, s[24:27], s51 offen offset:3072 nt
    s_add_u32 s51, s51, 32768
    v_cvt_f32_i32 v8, v80
    v_cvt_f32_i32 v9, v81
    v_cvt_f32_i32 v10, v82
    v_cvt_f32_i32 v11, v83
    v_cvt_pk_bf16_f32 v8, 0, v8
    v_cvt_pk_bf16_f32 v9, 0, v9
    v_cvt_pk_bf16_f32 v10, 0, v10
    v_cvt_pk_bf16_f32 v11, 0, v11
    v_sub_f32 v8, v8, v24
    v_sub_f32 v9, v9, v25
    v_sub_f32 v10, v10, v26
    v_sub_f32 v11, v11, v27
    v_cvt_pk_bf16_f32 v8, 0, v8
    v_cvt_pk_bf16_f32 v9, 0, v9
    v_cvt_pk_bf16_f32 v10, 0, v10
    v_cvt_pk_bf16_f32 v11, 0, v11
    v_mul_f32 v8, v8, v28
    v_mul_f32 v9, v9, v29
    v_mul_f32 v10, v10, v30
    v_mul_f32 v11, v11, v31
    v_cvt_pk_bf16_f32 v16, v8, v9
    v_cvt_pk_bf16_f32 v17, v10, v11
    v_dot2_f32_bf16 v52, v16, v32, 0
    v_dot2_f32_bf16 v53, v16, v34, 0
    v_dot2_f32_bf16 v52, v17, v33, v52
    v_dot2_f32_bf16 v53, v17, v35, v53
    s_waitcnt vmcnt(2)
    buffer_load_dwordx4 v[80:83], v1, s[24:27], s51 offen offset:0 nt
    v_cvt_f32_i32 v12, v84
    v_cvt_f32_i32 v13, v85
    v_cvt_f32_i32 v14, v86
    v_cvt_f32_i32 v15, v87
    v_cvt_pk_bf16_f32 v12, 0, v12
    v_cvt_pk_bf16_f32 v13, 0, v13
    v_cvt_pk_bf16_f32 v14, 0, v14
    v_cvt_pk_bf16_f32 v15, 0, v15
    v_sub_f32 v12, v12, v24
    v_sub_f32 v13, v13, v25
    v_sub_f32 v14, v14, v26
    v_sub_f32 v15, v15, v27
    v_cvt_pk_bf16_f32 v12, 0, v12
    v_cvt_pk_bf16_f32 v13, 0, v13
    v_cvt_pk_bf16_f32 v14, 0, v14
    v_cvt_pk_bf16_f32 v15, 0, v15
    v_mul_f32 v12, v12, v28
    v_mul_f32 v13, v13, v29
    v_mul_f32 v14, v14, v30
    v_mul_f32 v15, v15, v31
    v_cvt_pk_bf16_f32 v18, v12, v13
    v_cvt_pk_bf16_f32 v19, v14, v15
    v_dot2_f32_bf16 v54, v18, v32, 0
    v_dot2_f32_bf16 v55, v18, v34, 0
    v_dot2_f32_bf16 v54, v19, v33, v54
    v_dot2_f32_bf16 v55, v19, v35, v55
    s_waitcnt vmcnt(2)
    buffer_load_dwordx4 v[84:87], v1, s[24:27], s51 offen offset:1024 nt
    v_cvt_f32_i32 v8, v88
    v_cvt_f32_i32 v9, v89
    v_cvt_f32_i32 v10, v90
    v_cvt_f32_i32 v11, v91
    v_cvt_pk_bf16_f32 v8, 0, v8
    v_cvt_pk_bf16_f32 v9, 0, v9
    v_cvt_pk_bf16_f32 v10, 0, v10
    v_cvt_pk_bf16_f32 v11, 0, v11
    v_sub_f32 v8, v8, v24
    v_sub_f32 v9, v9, v25
    v_sub_f32 v10, v10, v26
    v_sub_f32 v11, v11, v27
    v_cvt_pk_bf16_f32 v8, 0, v8
    v_cvt_pk_bf16_f32 v9, 0, v9
    v_cvt_pk_bf16_f32 v10, 0, v10
    v_cvt_pk_bf16_f32 v11, 0, v11
    v_mul_f32 v8, v8, v28
    v_mul_f32 v9, v9, v29
    v_mul_f32 v10, v10, v30
    v_mul_f32 v11, v11, v31
    v_cvt_pk_bf16_f32 v16, v8, v9
    v_cvt_pk_bf16_f32 v17, v10, v11
    v_dot2_f32_bf16 v56, v16, v32, 0
    v_dot2_f32_bf16 v57, v16, v34, 0
    v_dot2_f32_bf16 v56, v17, v33, v56
    v_dot2_f32_bf16 v57, v17, v35, v57
    s_waitcnt vmcnt(2)
    buffer_load_dwordx4 v[88:91], v1, s[24:27], s51 offen offset:2048 nt
    v_cvt_f32_i32 v12, v92
    v_cvt_f32_i32 v13, v93
    v_cvt_f32_i32 v14, v94
    v_cvt_f32_i32 v15, v95
    v_cvt_pk_bf16_f32 v12, 0, v12
    v_cvt_pk_bf16_f32 v13, 0, v13
    v_cvt_pk_bf16_f32 v14, 0, v14
    v_cvt_pk_bf16_f32 v15, 0, v15
    v_sub_f32 v12, v12, v24
    v_sub_f32 v13, v13, v25
    v_sub_f32 v14, v14, v26
    v_sub_f32 v15, v15, v27
    v_cvt_pk_bf16_f32 v12, 0, v12
    v_cvt_pk_bf16_f32 v13, 0, v13
    v_cvt_pk_bf16_f32 v14, 0, v14
    v_cvt_pk_bf16_f32 v15, 0, v15
    v_mul_f32 v12, v12, v28
    v_mul_f32 v13, v13, v29
    v_mul_f32 v14, v14, v30
    v_mul_f32 v15, v15, v31
    v_cvt_pk_bf16_f32 v18, v12, v13
    v_cvt_pk_bf16_f32 v19, v14, v15
    v_dot2_f32_bf16 v58, v18, v32, 0
    v_dot2_f32_bf16 v59, v18, v34, 0
    v_dot2_f32_bf16 v58, v19, v33, v58
    v_dot2_f32_bf16 v59, v19, v35, v59
    v_permlane32_swap_b32 v44, v45
    v_permlane32_swap_b32 v46, v47
    v_permlane32_swap_b32 v48, v49
    v_permlane32_swap_b32 v50, v51
    v_permlane32_swap_b32 v52, v53
    v_permlane32_swap_b32 v54, v55
    v_permlane32_swap_b32 v56, v57
    v_permlane32_swap_b32 v58, v59
    v_add_f32 v44, v44, v45
    v_add_f32 v46, v46, v47
    v_add_f32 v48, v48, v49
    v_add_f32 v50, v50, v51
    v_add_f32 v52, v52, v53
    v_add_f32 v54, v54, v55
    v_add_f32 v56, v56, v57
    v_add_f32 v58, v58, v59
    v_permlane16_swap_b32 v44, v46
    v_permlane16_swap_b32 v48, v50
    v_permlane16_swap_b32 v52, v54
    v_permlane16_swap_b32 v56, v58
    v_add_f32 v44, v44, v46
    v_add_f32 v48, v48, v50
    v_add_f32 v52, v52, v54
    v_add_f32 v56, v56, v58
    v_add_f32_dpp v44, v44, v44 row_ror:8 row_mask:0xf bank_mask:0x3
    v_add_f32_dpp v44, v48, v48 row_ror:8 row_mask:0xf bank_mask:0xc
    v_add_f32_dpp v52, v52, v52 row_ror:8 row_mask:0xf bank_mask:0x3
    v_add_f32_dpp v52, v56, v56 row_ror:8 row_mask:0xf bank_mask:0xc
    v_add_f32_dpp v44, v44, v44 row_shl:4 row_mask:0xf bank_mask:0x5
    s_nop 0
    v_add_f32_dpp v44, v52, v52 row_shr:4 row_mask:0xf bank_mask:0xa
    s_nop 1
    v_add_f32_dpp v44, v44, v44 quad_perm:[1,0,3,2] row_mask:0xf bank_mask:0xf
    s_nop 1
    v_add_f32_dpp v44, v44, v44 quad_perm:[2,3,0,1] row_mask:0xf bank_mask:0xf
    ds_write_b32 v5, v44 offset:32
    v_add_u32 v5, 64, v5
    s_sub_u32 s42, s42, 1
    s_cmp_lg_u32 s42, 0
    s_nop 3
    s_cbranch_scc1 L_kloop
    s_waitcnt vmcnt(3)
    v_lshlrev_b32 v28, 16, v40
    v_and_b32 v29, 0xffff0000, v40
    v_lshlrev_b32 v30, 16, v41
    v_and_b32 v31, 0xffff0000, v41
    v_lshlrev_b32 v24, 16, v42
    v_and_b32 v25, 0xffff0000, v42
    v_lshlrev_b32 v26, 16, v43
    v_and_b32 v27, 0xffff0000, v43
    v_lshrrev_b32 v8, 1, v2
    v_mul_u32_u24 v8, 64, v8
    v_and_b32 v9, 1, v2
    v_lshl_add_u32 v8, v9, 2, v8
    s_lshl_b32 s41, s39, 1
    s_mov_b32 s32, s14
    s_and_b32 s33, s15, 0xffff
    s_mov_b32 s34, 524288
    s_mov_b32 s35, 0x00020000
    buffer_load_dword v4, v8, s[32:35], s41 offen
    s_mov_b32 s32, s16
    s_and_b32 s33, s17, 0xffff
    s_mov_b32 s34, 524288
    s_mov_b32 s35, 0x00020000
    buffer_load_dword v3, v8, s[32:35], s41 offen
    s_waitcnt vmcnt(4)
    buffer_load_dwordx4 v[92:95], v1, s[24:27], s51 offen offset:3072 nt
    s_add_u32 s51, s51, 32768
    v_cvt_f32_i32 v8, v80
    v_cvt_f32_i32 v9, v81
    v_cvt_f32_i32 v10, v82
    v_cvt_f32_i32 v11, v83
    v_cvt_pk_bf16_f32 v8, 0, v8
    v_cvt_pk_bf16_f32 v9, 0, v9
    v_cvt_pk_bf16_f32 v10, 0, v10
    v_cvt_pk_bf16_f32 v11, 0, v11
    v_sub_f32 v8, v8, v24
    v_sub_f32 v9, v9, v25
    v_sub_f32 v10, v10, v26
    v_sub_f32 v11, v11, v27
    v_cvt_pk_bf16_f32 v8, 0, v8
    v_cvt_pk_bf16_f32 v9, 0, v9
    v_cvt_pk_bf16_f32 v10, 0, v10
    v_cvt_pk_bf16_f32 v11, 0, v11
    v_mul_f32 v8, v8, v28
    v_mul_f32 v9, v9, v29
    v_mul_f32 v10, v10, v30
    v_mul_f32 v11, v11, v31
    v_cvt_pk_bf16_f32 v16, v8, v9
    v_cvt_pk_bf16_f32 v17, v10, v11
    v_dot2_f32_bf16 v44, v16, v32, 0
    v_dot2_f32_bf16 v45, v16, v34, 0
    v_dot2_f32_bf16 v44, v17, v33, v44
    v_dot2_f32_bf16 v45, v17, v35, v45
    s_waitcnt vmcnt(4)
    buffer_load_dwordx4 v[80:83], v1, s[24:27], s51 offen offset:0 nt
    v_cvt_f32_i32 v12, v84
    v_cvt_f32_i32 v13, v85
    v_cvt_f32_i32 v14, v86
    v_cvt_f32_i32 v15, v87
    v_cvt_pk_bf16_f32 v12, 0, v12
    v_cvt_pk_bf16_f32 v13, 0, v13
    v_cvt_pk_bf16_f32 v14, 0, v14
    v_cvt_pk_bf16_f32 v15, 0, v15
    v_sub_f32 v12, v12, v24
    v_sub_f32 v13, v13, v25
    v_sub_f32 v14, v14, v26
    v_sub_f32 v15, v15, v27
    v_cvt_pk_bf16_f32 v12, 0, v12
    v_cvt_pk_bf16_f32 v13, 0, v13
    v_cvt_pk_bf16_f32 v14, 0, v14
    v_cvt_pk_bf16_f32 v15, 0, v15
    v_mul_f32 v12, v12, v28
    v_mul_f32 v13, v13, v29
    v_mul_f32 v14, v14, v30
    v_mul_f32 v15, v15, v31
    v_cvt_pk_bf16_f32 v18, v12, v13
    v_cvt_pk_bf16_f32 v19, v14, v15
    v_dot2_f32_bf16 v46, v18, v32, 0
    v_dot2_f32_bf16 v47, v18, v34, 0
    v_dot2_f32_bf16 v46, v19, v33, v46
    v_dot2_f32_bf16 v47, v19, v35, v47
    s_waitcnt vmcnt(4)
    buffer_load_dwordx4 v[84:87], v1, s[24:27], s51 offen offset:1024 nt
    v_cvt_f32_i32 v8, v88
    v_cvt_f32_i32 v9, v89
    v_cvt_f32_i32 v10, v90
    v_cvt_f32_i32 v11, v91
    v_cvt_pk_bf16_f32 v8, 0, v8
    v_cvt_pk_bf16_f32 v9, 0, v9
    v_cvt_pk_bf16_f32 v10, 0, v10
    v_cvt_pk_bf16_f32 v11, 0, v11
    v_sub_f32 v8, v8, v24
    v_sub_f32 v9, v9, v25
    v_sub_f32 v10, v10, v26
    v_sub_f32 v11, v11, v27
    v_cvt_pk_bf16_f32 v8, 0, v8
    v_cvt_pk_bf16_f32 v9, 0, v9
    v_cvt_pk_bf16_f32 v10, 0, v10
    v_cvt_pk_bf16_f32 v11, 0, v11
    v_mul_f32 v8, v8, v28
    v_mul_f32 v9, v9, v29
    v_mul_f32 v10, v10, v30
    v_mul_f32 v11, v11, v31
    v_cvt_pk_bf16_f32 v16, v8, v9
    v_cvt_pk_bf16_f32 v17, v10, v11
    v_dot2_f32_bf16 v48, v16, v32, 0
    v_dot2_f32_bf16 v49, v16, v34, 0
    v_dot2_f32_bf16 v48, v17, v33, v48
    v_dot2_f32_bf16 v49, v17, v35, v49
    s_waitcnt vmcnt(2)
    buffer_load_dwordx4 v[88:91], v1, s[24:27], s51 offen offset:2048 nt
    v_cvt_f32_i32 v12, v92
    v_cvt_f32_i32 v13, v93
    v_cvt_f32_i32 v14, v94
    v_cvt_f32_i32 v15, v95
    v_cvt_pk_bf16_f32 v12, 0, v12
    v_cvt_pk_bf16_f32 v13, 0, v13
    v_cvt_pk_bf16_f32 v14, 0, v14
    v_cvt_pk_bf16_f32 v15, 0, v15
    v_sub_f32 v12, v12, v24
    v_sub_f32 v13, v13, v25
    v_sub_f32 v14, v14, v26
    v_sub_f32 v15, v15, v27
    v_cvt_pk_bf16_f32 v12, 0, v12
    v_cvt_pk_bf16_f32 v13, 0, v13
    v_cvt_pk_bf16_f32 v14, 0, v14
    v_cvt_pk_bf16_f32 v15, 0, v15
    v_mul_f32 v12, v12, v28
    v_mul_f32 v13, v13, v29
    v_mul_f32 v14, v14, v30
    v_mul_f32 v15, v15, v31
    v_cvt_pk_bf16_f32 v18, v12, v13
    v_cvt_pk_bf16_f32 v19, v14, v15
    v_dot2_f32_bf16 v50, v18, v32, 0
    v_dot2_f32_bf16 v51, v18, v34, 0
    v_dot2_f32_bf16 v50, v19, v33, v50
    v_dot2_f32_bf16 v51, v19, v35, v51
    s_waitcnt vmcnt(2)
    buffer_load_dwordx4 v[92:95], v1, s[24:27], s51 offen offset:3072 nt
    s_add_u32 s51, s51, 32768
    v_cvt_f32_i32 v8, v80
    v_cvt_f32_i32 v9, v81
    v_cvt_f32_i32 v10, v82
    v_cvt_f32_i32 v11, v83
    v_cvt_pk_bf16_f32 v8, 0, v8
    v_cvt_pk_bf16_f32 v9, 0, v9
    v_cvt_pk_bf16_f32 v10, 0, v10
    v_cvt_pk_bf16_f32 v11, 0, v11
    v_sub_f32 v8, v8, v24
    v_sub_f32 v9, v9, v25
    v_sub_f32 v10, v10, v26
    v_sub_f32 v11, v11, v27
    v_cvt_pk_bf16_f32 v8, 0, v8
    v_cvt_pk_bf16_f32 v9, 0, v9
    v_cvt_pk_bf16_f32 v10, 0, v10
    v_cvt_pk_bf16_f32 v11, 0, v11
    v_mul_f32 v8, v8, v28
    v_mul_f32 v9, v9, v29
    v_mul_f32 v10, v10, v30
    v_mul_f32 v11, v11, v31
    v_cvt_pk_bf16_f32 v16, v8, v9
    v_cvt_pk_bf16_f32 v17, v10, v11
    v_dot2_f32_bf16 v52, v16, v32, 0
    v_dot2_f32_bf16 v53, v16, v34, 0
    v_dot2_f32_bf16 v52, v17, v33, v52
    v_dot2_f32_bf16 v53, v17, v35, v53
    s_waitcnt vmcnt(2)
    buffer_load_dwordx4 v[80:83], v1, s[24:27], s51 offen offset:0 nt
    v_cvt_f32_i32 v12, v84
    v_cvt_f32_i32 v13, v85
    v_cvt_f32_i32 v14, v86
    v_cvt_f32_i32 v15, v87
    v_cvt_pk_bf16_f32 v12, 0, v12
    v_cvt_pk_bf16_f32 v13, 0, v13
    v_cvt_pk_bf16_f32 v14, 0, v14
    v_cvt_pk_bf16_f32 v15, 0, v15
    v_sub_f32 v12, v12, v24
    v_sub_f32 v13, v13, v25
    v_sub_f32 v14, v14, v26
    v_sub_f32 v15, v15, v27
    v_cvt_pk_bf16_f32 v12, 0, v12
    v_cvt_pk_bf16_f32 v13, 0, v13
    v_cvt_pk_bf16_f32 v14, 0, v14
    v_cvt_pk_bf16_f32 v15, 0, v15
    v_mul_f32 v12, v12, v28
    v_mul_f32 v13, v13, v29
    v_mul_f32 v14, v14, v30
    v_mul_f32 v15, v15, v31
    v_cvt_pk_bf16_f32 v18, v12, v13
    v_cvt_pk_bf16_f32 v19, v14, v15
    v_dot2_f32_bf16 v54, v18, v32, 0
    v_dot2_f32_bf16 v55, v18, v34, 0
    v_dot2_f32_bf16 v54, v19, v33, v54
    v_dot2_f32_bf16 v55, v19, v35, v55
    s_waitcnt vmcnt(2)
    buffer_load_dwordx4 v[84:87], v1, s[24:27], s51 offen offset:1024 nt
    v_cvt_f32_i32 v8, v88
    v_cvt_f32_i32 v9, v89
    v_cvt_f32_i32 v10, v90
    v_cvt_f32_i32 v11, v91
    v_cvt_pk_bf16_f32 v8, 0, v8
    v_cvt_pk_bf16_f32 v9, 0, v9
    v_cvt_pk_bf16_f32 v10, 0, v10
    v_cvt_pk_bf16_f32 v11, 0, v11
    v_sub_f32 v8, v8, v24
    v_sub_f32 v9, v9, v25
    v_sub_f32 v10, v10, v26
    v_sub_f32 v11, v11, v27
    v_cvt_pk_bf16_f32 v8, 0, v8
    v_cvt_pk_bf16_f32 v9, 0, v9
    v_cvt_pk_bf16_f32 v10, 0, v10
    v_cvt_pk_bf16_f32 v11, 0, v11
    v_mul_f32 v8, v8, v28
    v_mul_f32 v9, v9, v29
    v_mul_f32 v10, v10, v30
    v_mul_f32 v11, v11, v31
    v_cvt_pk_bf16_f32 v16, v8, v9
    v_cvt_pk_bf16_f32 v17, v10, v11
    v_dot2_f32_bf16 v56, v16, v32, 0
    v_dot2_f32_bf16 v57, v16, v34, 0
    v_dot2_f32_bf16 v56, v17, v33, v56
    v_dot2_f32_bf16 v57, v17, v35, v57
    s_waitcnt vmcnt(2)
    buffer_load_dwordx4 v[88:91], v1, s[24:27], s51 offen offset:2048 nt
    v_cvt_f32_i32 v12, v92
    v_cvt_f32_i32 v13, v93
    v_cvt_f32_i32 v14, v94
    v_cvt_f32_i32 v15, v95
    v_cvt_pk_bf16_f32 v12, 0, v12
    v_cvt_pk_bf16_f32 v13, 0, v13
    v_cvt_pk_bf16_f32 v14, 0, v14
    v_cvt_pk_bf16_f32 v15, 0, v15
    v_sub_f32 v12, v12, v24
    v_sub_f32 v13, v13, v25
    v_sub_f32 v14, v14, v26
    v_sub_f32 v15, v15, v27
    v_cvt_pk_bf16_f32 v12, 0, v12
    v_cvt_pk_bf16_f32 v13, 0, v13
    v_cvt_pk_bf16_f32 v14, 0, v14
    v_cvt_pk_bf16_f32 v15, 0, v15
    v_mul_f32 v12, v12, v28
    v_mul_f32 v13, v13, v29
    v_mul_f32 v14, v14, v30
    v_mul_f32 v15, v15, v31
    v_cvt_pk_bf16_f32 v18, v12, v13
    v_cvt_pk_bf16_f32 v19, v14, v15
    v_dot2_f32_bf16 v58, v18, v32, 0
    v_dot2_f32_bf16 v59, v18, v34, 0
    v_dot2_f32_bf16 v58, v19, v33, v58
    v_dot2_f32_bf16 v59, v19, v35, v59
    v_permlane32_swap_b32 v44, v45
    v_permlane32_swap_b32 v46, v47
    v_permlane32_swap_b32 v48, v49
    v_permlane32_swap_b32 v50, v51
    v_permlane32_swap_b32 v52, v53
    v_permlane32_swap_b32 v54, v55
    v_permlane32_swap_b32 v56, v57
    v_permlane32_swap_b32 v58, v59
    v_add_f32 v44, v44, v45
    v_add_f32 v46, v46, v47
    v_add_f32 v48, v48, v49
    v_add_f32 v50, v50, v51
    v_add_f32 v52, v52, v53
    v_add_f32 v54, v54, v55
    v_add_f32 v56, v56, v57
    v_add_f32 v58, v58, v59
    v_permlane16_swap_b32 v44, v46
    v_permlane16_swap_b32 v48, v50
    v_permlane16_swap_b32 v52, v54
    v_permlane16_swap_b32 v56, v58
    v_add_f32 v44, v44, v46
    v_add_f32 v48, v48, v50
    v_add_f32 v52, v52, v54
    v_add_f32 v56, v56, v58
    v_add_f32_dpp v44, v44, v44 row_ror:8 row_mask:0xf bank_mask:0x3
    v_add_f32_dpp v44, v48, v48 row_ror:8 row_mask:0xf bank_mask:0xc
    v_add_f32_dpp v52, v52, v52 row_ror:8 row_mask:0xf bank_mask:0x3
    v_add_f32_dpp v52, v56, v56 row_ror:8 row_mask:0xf bank_mask:0xc
    v_add_f32_dpp v44, v44, v44 row_shl:4 row_mask:0xf bank_mask:0x5
    s_nop 0
    v_add_f32_dpp v44, v52, v52 row_shr:4 row_mask:0xf bank_mask:0xa
    s_nop 1
    v_add_f32_dpp v44, v44, v44 quad_perm:[1,0,3,2] row_mask:0xf bank_mask:0xf
    s_nop 1
    v_add_f32_dpp v44, v44, v44 quad_perm:[2,3,0,1] row_mask:0xf bank_mask:0xf
    ds_write_b32 v5, v44 offset:0
    s_waitcnt vmcnt(2)
    buffer_load_dwordx4 v[92:95], v1, s[24:27], s51 offen offset:3072 nt
    s_add_u32 s51, s51, 32768
    v_cvt_f32_i32 v8, v80
    v_cvt_f32_i32 v9, v81
    v_cvt_f32_i32 v10, v82
    v_cvt_f32_i32 v11, v83
    v_cvt_pk_bf16_f32 v8, 0, v8
    v_cvt_pk_bf16_f32 v9, 0, v9
    v_cvt_pk_bf16_f32 v10, 0, v10
    v_cvt_pk_bf16_f32 v11, 0, v11
    v_sub_f32 v8, v8, v24
    v_sub_f32 v9, v9, v25
    v_sub_f32 v10, v10, v26
    v_sub_f32 v11, v11, v27
    v_cvt_pk_bf16_f32 v8, 0, v8
    v_cvt_pk_bf16_f32 v9, 0, v9
    v_cvt_pk_bf16_f32 v10, 0, v10
    v_cvt_pk_bf16_f32 v11, 0, v11
    v_mul_f32 v8, v8, v28
    v_mul_f32 v9, v9, v29
    v_mul_f32 v10, v10, v30
    v_mul_f32 v11, v11, v31
    v_cvt_pk_bf16_f32 v16, v8, v9
    v_cvt_pk_bf16_f32 v17, v10, v11
    v_dot2_f32_bf16 v44, v16, v32, 0
    v_dot2_f32_bf16 v45, v16, v34, 0
    v_dot2_f32_bf16 v44, v17, v33, v44
    v_dot2_f32_bf16 v45, v17, v35, v45
    s_waitcnt vmcnt(2)
    buffer_load_dwordx4 v[80:83], v1, s[24:27], s51 offen offset:0 nt
    v_cvt_f32_i32 v12, v84
    v_cvt_f32_i32 v13, v85
    v_cvt_f32_i32 v14, v86
    v_cvt_f32_i32 v15, v87
    v_cvt_pk_bf16_f32 v12, 0, v12
    v_cvt_pk_bf16_f32 v13, 0, v13
    v_cvt_pk_bf16_f32 v14, 0, v14
    v_cvt_pk_bf16_f32 v15, 0, v15
    v_sub_f32 v12, v12, v24
    v_sub_f32 v13, v13, v25
    v_sub_f32 v14, v14, v26
    v_sub_f32 v15, v15, v27
    v_cvt_pk_bf16_f32 v12, 0, v12
    v_cvt_pk_bf16_f32 v13, 0, v13
    v_cvt_pk_bf16_f32 v14, 0, v14
    v_cvt_pk_bf16_f32 v15, 0, v15
    v_mul_f32 v12, v12, v28
    v_mul_f32 v13, v13, v29
    v_mul_f32 v14, v14, v30
    v_mul_f32 v15, v15, v31
    v_cvt_pk_bf16_f32 v18, v12, v13
    v_cvt_pk_bf16_f32 v19, v14, v15
    v_dot2_f32_bf16 v46, v18, v32, 0
    v_dot2_f32_bf16 v47, v18, v34, 0
    v_dot2_f32_bf16 v46, v19, v33, v46
    v_dot2_f32_bf16 v47, v19, v35, v47
    s_waitcnt vmcnt(2)
    buffer_load_dwordx4 v[84:87], v1, s[24:27], s51 offen offset:1024 nt
    v_cvt_f32_i32 v8, v88
    v_cvt_f32_i32 v9, v89
    v_cvt_f32_i32 v10, v90
    v_cvt_f32_i32 v11, v91
    v_cvt_pk_bf16_f32 v8, 0, v8
    v_cvt_pk_bf16_f32 v9, 0, v9
    v_cvt_pk_bf16_f32 v10, 0, v10
    v_cvt_pk_bf16_f32 v11, 0, v11
    v_sub_f32 v8, v8, v24
    v_sub_f32 v9, v9, v25
    v_sub_f32 v10, v10, v26
    v_sub_f32 v11, v11, v27
    v_cvt_pk_bf16_f32 v8, 0, v8
    v_cvt_pk_bf16_f32 v9, 0, v9
    v_cvt_pk_bf16_f32 v10, 0, v10
    v_cvt_pk_bf16_f32 v11, 0, v11
    v_mul_f32 v8, v8, v28
    v_mul_f32 v9, v9, v29
    v_mul_f32 v10, v10, v30
    v_mul_f32 v11, v11, v31
    v_cvt_pk_bf16_f32 v16, v8, v9
    v_cvt_pk_bf16_f32 v17, v10, v11
    v_dot2_f32_bf16 v48, v16, v32, 0
    v_dot2_f32_bf16 v49, v16, v34, 0
    v_dot2_f32_bf16 v48, v17, v33, v48
    v_dot2_f32_bf16 v49, v17, v35, v49
    s_waitcnt vmcnt(2)
    buffer_load_dwordx4 v[88:91], v1, s[24:27], s51 offen offset:2048 nt
    v_cvt_f32_i32 v12, v92
    v_cvt_f32_i32 v13, v93
    v_cvt_f32_i32 v14, v94
    v_cvt_f32_i32 v15, v95
    v_cvt_pk_bf16_f32 v12, 0, v12
    v_cvt_pk_bf16_f32 v13, 0, v13
    v_cvt_pk_bf16_f32 v14, 0, v14
    v_cvt_pk_bf16_f32 v15, 0, v15
    v_sub_f32 v12, v12, v24
    v_sub_f32 v13, v13, v25
    v_sub_f32 v14, v14, v26
    v_sub_f32 v15, v15, v27
    v_cvt_pk_bf16_f32 v12, 0, v12
    v_cvt_pk_bf16_f32 v13, 0, v13
    v_cvt_pk_bf16_f32 v14, 0, v14
    v_cvt_pk_bf16_f32 v15, 0, v15
    v_mul_f32 v12, v12, v28
    v_mul_f32 v13, v13, v29
    v_mul_f32 v14, v14, v30
    v_mul_f32 v15, v15, v31
    v_cvt_pk_bf16_f32 v18, v12, v13
    v_cvt_pk_bf16_f32 v19, v14, v15
    v_dot2_f32_bf16 v50, v18, v32, 0
    v_dot2_f32_bf16 v51, v18, v34, 0
    v_dot2_f32_bf16 v50, v19, v33, v50
    v_dot2_f32_bf16 v51, v19, v35, v51
    s_waitcnt vmcnt(2)
    buffer_load_dwordx4 v[92:95], v1, s[24:27], s51 offen offset:3072 nt
    s_add_u32 s51, s51, 32768
    v_cvt_f32_i32 v8, v80
    v_cvt_f32_i32 v9, v81
    v_cvt_f32_i32 v10, v82
    v_cvt_f32_i32 v11, v83
    v_cvt_pk_bf16_f32 v8, 0, v8
    v_cvt_pk_bf16_f32 v9, 0, v9
    v_cvt_pk_bf16_f32 v10, 0, v10
    v_cvt_pk_bf16_f32 v11, 0, v11
    v_sub_f32 v8, v8, v24
    v_sub_f32 v9, v9, v25
    v_sub_f32 v10, v10, v26
    v_sub_f32 v11, v11, v27
    v_cvt_pk_bf16_f32 v8, 0, v8
    v_cvt_pk_bf16_f32 v9, 0, v9
    v_cvt_pk_bf16_f32 v10, 0, v10
    v_cvt_pk_bf16_f32 v11, 0, v11
    v_mul_f32 v8, v8, v28
    v_mul_f32 v9, v9, v29
    v_mul_f32 v10, v10, v30
    v_mul_f32 v11, v11, v31
    v_cvt_pk_bf16_f32 v16, v8, v9
    v_cvt_pk_bf16_f32 v17, v10, v11
    v_dot2_f32_bf16 v52, v16, v32, 0
    v_dot2_f32_bf16 v53, v16, v34, 0
    v_dot2_f32_bf16 v52, v17, v33, v52
    v_dot2_f32_bf16 v53, v17, v35, v53
    s_lshl_b32 s51, s39, 10
    s_waitcnt vmcnt(2)
    buffer_load_dwordx4 v[80:83], v1, s[28:31], s51 offen offset:0 nt
    v_cvt_f32_i32 v12, v84
    v_cvt_f32_i32 v13, v85
    v_cvt_f32_i32 v14, v86
    v_cvt_f32_i32 v15, v87
    v_cvt_pk_bf16_f32 v12, 0, v12
    v_cvt_pk_bf16_f32 v13, 0, v13
    v_cvt_pk_bf16_f32 v14, 0, v14
    v_cvt_pk_bf16_f32 v15, 0, v15
    v_sub_f32 v12, v12, v24
    v_sub_f32 v13, v13, v25
    v_sub_f32 v14, v14, v26
    v_sub_f32 v15, v15, v27
    v_cvt_pk_bf16_f32 v12, 0, v12
    v_cvt_pk_bf16_f32 v13, 0, v13
    v_cvt_pk_bf16_f32 v14, 0, v14
    v_cvt_pk_bf16_f32 v15, 0, v15
    v_mul_f32 v12, v12, v28
    v_mul_f32 v13, v13, v29
    v_mul_f32 v14, v14, v30
    v_mul_f32 v15, v15, v31
    v_cvt_pk_bf16_f32 v18, v12, v13
    v_cvt_pk_bf16_f32 v19, v14, v15
    v_dot2_f32_bf16 v54, v18, v32, 0
    v_dot2_f32_bf16 v55, v18, v34, 0
    v_dot2_f32_bf16 v54, v19, v33, v54
    v_dot2_f32_bf16 v55, v19, v35, v55
    s_waitcnt vmcnt(2)
    buffer_load_dwordx4 v[84:87], v1, s[28:31], s51 offen offset:1024 nt
    v_cvt_f32_i32 v8, v88
    v_cvt_f32_i32 v9, v89
    v_cvt_f32_i32 v10, v90
    v_cvt_f32_i32 v11, v91
    v_cvt_pk_bf16_f32 v8, 0, v8
    v_cvt_pk_bf16_f32 v9, 0, v9
    v_cvt_pk_bf16_f32 v10, 0, v10
    v_cvt_pk_bf16_f32 v11, 0, v11
    v_sub_f32 v8, v8, v24
    v_sub_f32 v9, v9, v25
    v_sub_f32 v10, v10, v26
    v_sub_f32 v11, v11, v27
    v_cvt_pk_bf16_f32 v8, 0, v8
    v_cvt_pk_bf16_f32 v9, 0, v9
    v_cvt_pk_bf16_f32 v10, 0, v10
    v_cvt_pk_bf16_f32 v11, 0, v11
    v_mul_f32 v8, v8, v28
    v_mul_f32 v9, v9, v29
    v_mul_f32 v10, v10, v30
    v_mul_f32 v11, v11, v31
    v_cvt_pk_bf16_f32 v16, v8, v9
    v_cvt_pk_bf16_f32 v17, v10, v11
    v_dot2_f32_bf16 v56, v16, v32, 0
    v_dot2_f32_bf16 v57, v16, v34, 0
    v_dot2_f32_bf16 v56, v17, v33, v56
    v_dot2_f32_bf16 v57, v17, v35, v57
    s_waitcnt vmcnt(2)
    buffer_load_dwordx4 v[88:91], v1, s[28:31], s51 offen offset:2048 nt
    v_cvt_f32_i32 v12, v92
    v_cvt_f32_i32 v13, v93
    v_cvt_f32_i32 v14, v94
    v_cvt_f32_i32 v15, v95
    v_cvt_pk_bf16_f32 v12, 0, v12
    v_cvt_pk_bf16_f32 v13, 0, v13
    v_cvt_pk_bf16_f32 v14, 0, v14
    v_cvt_pk_bf16_f32 v15, 0, v15
    v_sub_f32 v12, v12, v24
    v_sub_f32 v13, v13, v25
    v_sub_f32 v14, v14, v26
    v_sub_f32 v15, v15, v27
    v_cvt_pk_bf16_f32 v12, 0, v12
    v_cvt_pk_bf16_f32 v13, 0, v13
    v_cvt_pk_bf16_f32 v14, 0, v14
    v_cvt_pk_bf16_f32 v15, 0, v15
    v_mul_f32 v12, v12, v28
    v_mul_f32 v13, v13, v29
    v_mul_f32 v14, v14, v30
    v_mul_f32 v15, v15, v31
    v_cvt_pk_bf16_f32 v18, v12, v13
    v_cvt_pk_bf16_f32 v19, v14, v15
    v_dot2_f32_bf16 v58, v18, v32, 0
    v_dot2_f32_bf16 v59, v18, v34, 0
    v_dot2_f32_bf16 v58, v19, v33, v58
    v_dot2_f32_bf16 v59, v19, v35, v59
    v_permlane32_swap_b32 v44, v45
    v_permlane32_swap_b32 v46, v47
    v_permlane32_swap_b32 v48, v49
    v_permlane32_swap_b32 v50, v51
    v_permlane32_swap_b32 v52, v53
    v_permlane32_swap_b32 v54, v55
    v_permlane32_swap_b32 v56, v57
    v_permlane32_swap_b32 v58, v59
    v_add_f32 v44, v44, v45
    v_add_f32 v46, v46, v47
    v_add_f32 v48, v48, v49
    v_add_f32 v50, v50, v51
    v_add_f32 v52, v52, v53
    v_add_f32 v54, v54, v55
    v_add_f32 v56, v56, v57
    v_add_f32 v58, v58, v59
    v_permlane16_swap_b32 v44, v46
    v_permlane16_swap_b32 v48, v50
    v_permlane16_swap_b32 v52, v54
    v_permlane16_swap_b32 v56, v58
    v_add_f32 v44, v44, v46
    v_add_f32 v48, v48, v50
    v_add_f32 v52, v52, v54
    v_add_f32 v56, v56, v58
    v_add_f32_dpp v44, v44, v44 row_ror:8 row_mask:0xf bank_mask:0x3
    v_add_f32_dpp v44, v48, v48 row_ror:8 row_mask:0xf bank_mask:0xc
    v_add_f32_dpp v52, v52, v52 row_ror:8 row_mask:0xf bank_mask:0x3
    v_add_f32_dpp v52, v56, v56 row_ror:8 row_mask:0xf bank_mask:0xc
    v_add_f32_dpp v44, v44, v44 row_shl:4 row_mask:0xf bank_mask:0x5
    s_nop 0
    v_add_f32_dpp v44, v52, v52 row_shr:4 row_mask:0xf bank_mask:0xa
    s_nop 1
    v_add_f32_dpp v44, v44, v44 quad_perm:[1,0,3,2] row_mask:0xf bank_mask:0xf
    s_nop 1
    v_add_f32_dpp v44, v44, v44 quad_perm:[2,3,0,1] row_mask:0xf bank_mask:0xf
    ds_write_b32 v5, v44 offset:32
    s_lshl_b32 s40, s38, 11
    v_lshlrev_b32 v38, 4, v2
    v_add_u32 v38, s40, v38
    s_waitcnt lgkmcnt(0)
    ds_read_b128 v[8:11], v38
    s_waitcnt lgkmcnt(0)
    v_cvt_pk_bf16_f32 v8, 0, v8
    v_cvt_pk_bf16_f32 v9, 0, v9
    v_cvt_pk_bf16_f32 v10, 0, v10
    v_cvt_pk_bf16_f32 v11, 0, v11
    v_max_f32 v36, v8, v9
    v_max3_f32 v36, v36, v10, v11
    s_nop 1
    v_max_f32_dpp v36, v36, v36 quad_perm:[1,0,3,2] row_mask:0xf bank_mask:0xf
    s_nop 1
    v_max_f32_dpp v36, v36, v36 quad_perm:[2,3,0,1] row_mask:0xf bank_mask:0xf
    s_nop 1
    v_max_f32_dpp v36, v36, v36 row_ror:4 row_mask:0xf bank_mask:0xf
    s_nop 1
    v_max_f32_dpp v36, v36, v36 row_ror:8 row_mask:0xf bank_mask:0xf
    v_mov_b32 v39, v36
    s_nop 1
    v_permlane16_swap_b32 v36, v39
    v_max_f32 v36, v36, v39
    v_sub_f32 v8, v8, v36
    v_sub_f32 v9, v9, v36
    v_sub_f32 v10, v10, v36
    v_sub_f32 v11, v11, v36
    v_mul_f32 v8, s50, v8
    v_mul_f32 v9, s50, v9
    v_mul_f32 v10, s50, v10
    v_mul_f32 v11, s50, v11
    v_exp_f32 v8, v8
    v_exp_f32 v9, v9
    v_exp_f32 v10, v10
    v_exp_f32 v11, v11
    v_lshlrev_b32 v38, 3, v2
    v_add_u32 v38, s40, v38
    v_cvt_pk_bf16_f32 v12, v8, v9
    v_cvt_pk_bf16_f32 v13, v10, v11
    ds_write_b64 v38, v[12:13] offset:1024
    v_add_f32 v37, v8, v9
    v_add_f32 v10, v10, v11
    v_add_f32 v37, v37, v10
    s_nop 1
    v_add_f32_dpp v37, v37, v37 quad_perm:[1,0,3,2] row_mask:0xf bank_mask:0xf
    s_nop 1
    v_add_f32_dpp v37, v37, v37 quad_perm:[2,3,0,1] row_mask:0xf bank_mask:0xf
    s_nop 1
    v_add_f32_dpp v37, v37, v37 row_ror:4 row_mask:0xf bank_mask:0xf
    s_nop 1
    v_add_f32_dpp v37, v37, v37 row_ror:8 row_mask:0xf bank_mask:0xf
    v_mov_b32 v39, v37
    s_nop 1
    v_permlane16_swap_b32 v37, v39
    v_add_f32 v37, v37, v39
    s_waitcnt lgkmcnt(0)
    s_mov_b32 s43, 0
    s_mov_b32 s42, 7
    s_nop 3
L_vloop:
    ds_read_b128 v[40:43], v6 offset:0
    v_readlane_b32 s48, v3, s43
    v_readlane_b32 s49, v4, s43
    s_add_u32 s43, s43, 1
    s_nop 0
    s_lshl_b32 s44, s48, 16
    s_and_b32 s45, s48, 0xffff0000
    s_lshl_b32 s46, s49, 16
    s_and_b32 s47, s49, 0xffff0000
    s_waitcnt vmcnt(2)
    buffer_load_dwordx4 v[92:95], v1, s[28:31], s51 offen offset:3072 nt
    s_add_u32 s51, s51, 32768
    v_cvt_f32_i32 v8, v80
    v_cvt_f32_i32 v9, v81
    v_cvt_f32_i32 v10, v82
    v_cvt_f32_i32 v11, v83
    v_cvt_pk_bf16_f32 v8, 0, v8
    v_cvt_pk_bf16_f32 v9, 0, v9
    v_cvt_pk_bf16_f32 v10, 0, v10
    v_cvt_pk_bf16_f32 v11, 0, v11
    v_subrev_f32 v8, s44, v8
    v_subrev_f32 v9, s44, v9
    v_subrev_f32 v10, s44, v10
    v_subrev_f32 v11, s44, v11
    v_cvt_pk_bf16_f32 v8, 0, v8
    v_cvt_pk_bf16_f32 v9, 0, v9
    v_cvt_pk_bf16_f32 v10, 0, v10
    v_cvt_pk_bf16_f32 v11, 0, v11
    v_mul_f32 v8, s46, v8
    v_mul_f32 v9, s46, v9
    v_mul_f32 v10, s46, v10
    v_mul_f32 v11, s46, v11
    s_waitcnt vmcnt(2)
    buffer_load_dwordx4 v[80:83], v1, s[28:31], s51 offen offset:0 nt
    v_cvt_f32_i32 v12, v84
    v_cvt_f32_i32 v13, v85
    v_cvt_f32_i32 v14, v86
    v_cvt_f32_i32 v15, v87
    v_cvt_pk_bf16_f32 v12, 0, v12
    v_cvt_pk_bf16_f32 v13, 0, v13
    v_cvt_pk_bf16_f32 v14, 0, v14
    v_cvt_pk_bf16_f32 v15, 0, v15
    v_subrev_f32 v12, s45, v12
    v_subrev_f32 v13, s45, v13
    v_subrev_f32 v14, s45, v14
    v_subrev_f32 v15, s45, v15
    v_cvt_pk_bf16_f32 v12, 0, v12
    v_cvt_pk_bf16_f32 v13, 0, v13
    v_cvt_pk_bf16_f32 v14, 0, v14
    v_cvt_pk_bf16_f32 v15, 0, v15
    v_mul_f32 v12, s47, v12
    v_mul_f32 v13, s47, v13
    v_mul_f32 v14, s47, v14
    v_mul_f32 v15, s47, v15
    v_cvt_pk_bf16_f32 v44, v8, v12
    v_cvt_pk_bf16_f32 v48, v9, v13
    v_cvt_pk_bf16_f32 v52, v10, v14
    v_cvt_pk_bf16_f32 v56, v11, v15
    v_readlane_b32 s48, v3, s43
    v_readlane_b32 s49, v4, s43
    s_add_u32 s43, s43, 1
    s_nop 0
    s_lshl_b32 s44, s48, 16
    s_and_b32 s45, s48, 0xffff0000
    s_lshl_b32 s46, s49, 16
    s_and_b32 s47, s49, 0xffff0000
    s_waitcnt vmcnt(2)
    buffer_load_dwordx4 v[84:87], v1, s[28:31], s51 offen offset:1024 nt
    v_cvt_f32_i32 v8, v88
    v_cvt_f32_i32 v9, v89
    v_cvt_f32_i32 v10, v90
    v_cvt_f32_i32 v11, v91
    v_cvt_pk_bf16_f32 v8, 0, v8
    v_cvt_pk_bf16_f32 v9, 0, v9
    v_cvt_pk_bf16_f32 v10, 0, v10
    v_cvt_pk_bf16_f32 v11, 0, v11
    v_subrev_f32 v8, s44, v8
    v_subrev_f32 v9, s44, v9
    v_subrev_f32 v10, s44, v10
    v_subrev_f32 v11, s44, v11
    v_cvt_pk_bf16_f32 v8, 0, v8
    v_cvt_pk_bf16_f32 v9, 0, v9
    v_cvt_pk_bf16_f32 v10, 0, v10
    v_cvt_pk_bf16_f32 v11, 0, v11
    v_mul_f32 v8, s46, v8
    v_mul_f32 v9, s46, v9
    v_mul_f32 v10, s46, v10
    v_mul_f32 v11, s46, v11
    s_waitcnt vmcnt(2)
    buffer_load_dwordx4 v[88:91], v1, s[28:31], s51 offen offset:2048 nt
    v_cvt_f32_i32 v12, v92
    v_cvt_f32_i32 v13, v93
    v_cvt_f32_i32 v14, v94
    v_cvt_f32_i32 v15, v95
    v_cvt_pk_bf16_f32 v12, 0, v12
    v_cvt_pk_bf16_f32 v13, 0, v13
    v_cvt_pk_bf16_f32 v14, 0, v14
    v_cvt_pk_bf16_f32 v15, 0, v15
    v_subrev_f32 v12, s45, v12
    v_subrev_f32 v13, s45, v13
    v_subrev_f32 v14, s45, v14
    v_subrev_f32 v15, s45, v15
    v_cvt_pk_bf16_f32 v12, 0, v12
    v_cvt_pk_bf16_f32 v13, 0, v13
    v_cvt_pk_bf16_f32 v14, 0, v14
    v_cvt_pk_bf16_f32 v15, 0, v15
    v_mul_f32 v12, s47, v12
    v_mul_f32 v13, s47, v13
    v_mul_f32 v14, s47, v14
    v_mul_f32 v15, s47, v15
    v_cvt_pk_bf16_f32 v45, v8, v12
    v_cvt_pk_bf16_f32 v49, v9, v13
    v_cvt_pk_bf16_f32 v53, v10, v14
    v_cvt_pk_bf16_f32 v57, v11, v15
    v_readlane_b32 s48, v3, s43
    v_readlane_b32 s49, v4, s43
    s_add_u32 s43, s43, 1
    s_nop 0
    s_lshl_b32 s44, s48, 16
    s_and_b32 s45, s48, 0xffff0000
    s_lshl_b32 s46, s49, 16
    s_and_b32 s47, s49, 0xffff0000
    s_waitcnt vmcnt(2)
    buffer_load_dwordx4 v[92:95], v1, s[28:31], s51 offen offset:3072 nt
    s_add_u32 s51, s51, 32768
    v_cvt_f32_i32 v8, v80
    v_cvt_f32_i32 v9, v81
    v_cvt_f32_i32 v10, v82
    v_cvt_f32_i32 v11, v83
    v_cvt_pk_bf16_f32 v8, 0, v8
    v_cvt_pk_bf16_f32 v9, 0, v9
    v_cvt_pk_bf16_f32 v10, 0, v10
    v_cvt_pk_bf16_f32 v11, 0, v11
    v_subrev_f32 v8, s44, v8
    v_subrev_f32 v9, s44, v9
    v_subrev_f32 v10, s44, v10
    v_subrev_f32 v11, s44, v11
    v_cvt_pk_bf16_f32 v8, 0, v8
    v_cvt_pk_bf16_f32 v9, 0, v9
    v_cvt_pk_bf16_f32 v10, 0, v10
    v_cvt_pk_bf16_f32 v11, 0, v11
    v_mul_f32 v8, s46, v8
    v_mul_f32 v9, s46, v9
    v_mul_f32 v10, s46, v10
    v_mul_f32 v11, s46, v11
    s_waitcnt vmcnt(2)
    buffer_load_dwordx4 v[80:83], v1, s[28:31], s51 offen offset:0 nt
    v_cvt_f32_i32 v12, v84
    v_cvt_f32_i32 v13, v85
    v_cvt_f32_i32 v14, v86
    v_cvt_f32_i32 v15, v87
    v_cvt_pk_bf16_f32 v12, 0, v12
    v_cvt_pk_bf16_f32 v13, 0, v13
    v_cvt_pk_bf16_f32 v14, 0, v14
    v_cvt_pk_bf16_f32 v15, 0, v15
    v_subrev_f32 v12, s45, v12
    v_subrev_f32 v13, s45, v13
    v_subrev_f32 v14, s45, v14
    v_subrev_f32 v15, s45, v15
    v_cvt_pk_bf16_f32 v12, 0, v12
    v_cvt_pk_bf16_f32 v13, 0, v13
    v_cvt_pk_bf16_f32 v14, 0, v14
    v_cvt_pk_bf16_f32 v15, 0, v15
    v_mul_f32 v12, s47, v12
    v_mul_f32 v13, s47, v13
    v_mul_f32 v14, s47, v14
    v_mul_f32 v15, s47, v15
    v_cvt_pk_bf16_f32 v46, v8, v12
    v_cvt_pk_bf16_f32 v50, v9, v13
    v_cvt_pk_bf16_f32 v54, v10, v14
    v_cvt_pk_bf16_f32 v58, v11, v15
    v_readlane_b32 s48, v3, s43
    v_readlane_b32 s49, v4, s43
    s_add_u32 s43, s43, 1
    s_nop 0
    s_lshl_b32 s44, s48, 16
    s_and_b32 s45, s48, 0xffff0000
    s_lshl_b32 s46, s49, 16
    s_and_b32 s47, s49, 0xffff0000
    s_waitcnt vmcnt(2)
    buffer_load_dwordx4 v[84:87], v1, s[28:31], s51 offen offset:1024 nt
    v_cvt_f32_i32 v8, v88
    v_cvt_f32_i32 v9, v89
    v_cvt_f32_i32 v10, v90
    v_cvt_f32_i32 v11, v91
    v_cvt_pk_bf16_f32 v8, 0, v8
    v_cvt_pk_bf16_f32 v9, 0, v9
    v_cvt_pk_bf16_f32 v10, 0, v10
    v_cvt_pk_bf16_f32 v11, 0, v11
    v_subrev_f32 v8, s44, v8
    v_subrev_f32 v9, s44, v9
    v_subrev_f32 v10, s44, v10
    v_subrev_f32 v11, s44, v11
    v_cvt_pk_bf16_f32 v8, 0, v8
    v_cvt_pk_bf16_f32 v9, 0, v9
    v_cvt_pk_bf16_f32 v10, 0, v10
    v_cvt_pk_bf16_f32 v11, 0, v11
    v_mul_f32 v8, s46, v8
    v_mul_f32 v9, s46, v9
    v_mul_f32 v10, s46, v10
    v_mul_f32 v11, s46, v11
    s_waitcnt vmcnt(2)
    buffer_load_dwordx4 v[88:91], v1, s[28:31], s51 offen offset:2048 nt
    v_cvt_f32_i32 v12, v92
    v_cvt_f32_i32 v13, v93
    v_cvt_f32_i32 v14, v94
    v_cvt_f32_i32 v15, v95
    v_cvt_pk_bf16_f32 v12, 0, v12
    v_cvt_pk_bf16_f32 v13, 0, v13
    v_cvt_pk_bf16_f32 v14, 0, v14
    v_cvt_pk_bf16_f32 v15, 0, v15
    v_subrev_f32 v12, s45, v12
    v_subrev_f32 v13, s45, v13
    v_subrev_f32 v14, s45, v14
    v_subrev_f32 v15, s45, v15
    v_cvt_pk_bf16_f32 v12, 0, v12
    v_cvt_pk_bf16_f32 v13, 0, v13
    v_cvt_pk_bf16_f32 v14, 0, v14
    v_cvt_pk_bf16_f32 v15, 0, v15
    v_mul_f32 v12, s47, v12
    v_mul_f32 v13, s47, v13
    v_mul_f32 v14, s47, v14
    v_mul_f32 v15, s47, v15
    v_cvt_pk_bf16_f32 v47, v8, v12
    v_cvt_pk_bf16_f32 v51, v9, v13
    v_cvt_pk_bf16_f32 v55, v10, v14
    v_cvt_pk_bf16_f32 v59, v11, v15
    s_waitcnt lgkmcnt(0)
    v_mfma_f32_16x16x32_bf16 v[60:63], v[40:43], v[44:47], v[60:63]
    v_mfma_f32_16x16x32_bf16 v[64:67], v[40:43], v[48:51], v[64:67]
    v_mfma_f32_16x16x32_bf16 v[68:71], v[40:43], v[52:55], v[68:71]
    v_mfma_f32_16x16x32_bf16 v[72:75], v[40:43], v[56:59], v[72:75]
    ds_read_b128 v[40:43], v6 offset:16
    v_readlane_b32 s48, v3, s43
    v_readlane_b32 s49, v4, s43
    s_add_u32 s43, s43, 1
    s_nop 0
    s_lshl_b32 s44, s48, 16
    s_and_b32 s45, s48, 0xffff0000
    s_lshl_b32 s46, s49, 16
    s_and_b32 s47, s49, 0xffff0000
    s_waitcnt vmcnt(2)
    buffer_load_dwordx4 v[92:95], v1, s[28:31], s51 offen offset:3072 nt
    s_add_u32 s51, s51, 32768
    v_cvt_f32_i32 v8, v80
    v_cvt_f32_i32 v9, v81
    v_cvt_f32_i32 v10, v82
    v_cvt_f32_i32 v11, v83
    v_cvt_pk_bf16_f32 v8, 0, v8
    v_cvt_pk_bf16_f32 v9, 0, v9
    v_cvt_pk_bf16_f32 v10, 0, v10
    v_cvt_pk_bf16_f32 v11, 0, v11
    v_subrev_f32 v8, s44, v8
    v_subrev_f32 v9, s44, v9
    v_subrev_f32 v10, s44, v10
    v_subrev_f32 v11, s44, v11
    v_cvt_pk_bf16_f32 v8, 0, v8
    v_cvt_pk_bf16_f32 v9, 0, v9
    v_cvt_pk_bf16_f32 v10, 0, v10
    v_cvt_pk_bf16_f32 v11, 0, v11
    v_mul_f32 v8, s46, v8
    v_mul_f32 v9, s46, v9
    v_mul_f32 v10, s46, v10
    v_mul_f32 v11, s46, v11
    s_waitcnt vmcnt(2)
    buffer_load_dwordx4 v[80:83], v1, s[28:31], s51 offen offset:0 nt
    v_cvt_f32_i32 v12, v84
    v_cvt_f32_i32 v13, v85
    v_cvt_f32_i32 v14, v86
    v_cvt_f32_i32 v15, v87
    v_cvt_pk_bf16_f32 v12, 0, v12
    v_cvt_pk_bf16_f32 v13, 0, v13
    v_cvt_pk_bf16_f32 v14, 0, v14
    v_cvt_pk_bf16_f32 v15, 0, v15
    v_subrev_f32 v12, s45, v12
    v_subrev_f32 v13, s45, v13
    v_subrev_f32 v14, s45, v14
    v_subrev_f32 v15, s45, v15
    v_cvt_pk_bf16_f32 v12, 0, v12
    v_cvt_pk_bf16_f32 v13, 0, v13
    v_cvt_pk_bf16_f32 v14, 0, v14
    v_cvt_pk_bf16_f32 v15, 0, v15
    v_mul_f32 v12, s47, v12
    v_mul_f32 v13, s47, v13
    v_mul_f32 v14, s47, v14
    v_mul_f32 v15, s47, v15
    v_cvt_pk_bf16_f32 v44, v8, v12
    v_cvt_pk_bf16_f32 v48, v9, v13
    v_cvt_pk_bf16_f32 v52, v10, v14
    v_cvt_pk_bf16_f32 v56, v11, v15
    v_readlane_b32 s48, v3, s43
    v_readlane_b32 s49, v4, s43
    s_add_u32 s43, s43, 1
    s_nop 0
    s_lshl_b32 s44, s48, 16
    s_and_b32 s45, s48, 0xffff0000
    s_lshl_b32 s46, s49, 16
    s_and_b32 s47, s49, 0xffff0000
    s_waitcnt vmcnt(2)
    buffer_load_dwordx4 v[84:87], v1, s[28:31], s51 offen offset:1024 nt
    v_cvt_f32_i32 v8, v88
    v_cvt_f32_i32 v9, v89
    v_cvt_f32_i32 v10, v90
    v_cvt_f32_i32 v11, v91
    v_cvt_pk_bf16_f32 v8, 0, v8
    v_cvt_pk_bf16_f32 v9, 0, v9
    v_cvt_pk_bf16_f32 v10, 0, v10
    v_cvt_pk_bf16_f32 v11, 0, v11
    v_subrev_f32 v8, s44, v8
    v_subrev_f32 v9, s44, v9
    v_subrev_f32 v10, s44, v10
    v_subrev_f32 v11, s44, v11
    v_cvt_pk_bf16_f32 v8, 0, v8
    v_cvt_pk_bf16_f32 v9, 0, v9
    v_cvt_pk_bf16_f32 v10, 0, v10
    v_cvt_pk_bf16_f32 v11, 0, v11
    v_mul_f32 v8, s46, v8
    v_mul_f32 v9, s46, v9
    v_mul_f32 v10, s46, v10
    v_mul_f32 v11, s46, v11
    s_waitcnt vmcnt(2)
    buffer_load_dwordx4 v[88:91], v1, s[28:31], s51 offen offset:2048 nt
    v_cvt_f32_i32 v12, v92
    v_cvt_f32_i32 v13, v93
    v_cvt_f32_i32 v14, v94
    v_cvt_f32_i32 v15, v95
    v_cvt_pk_bf16_f32 v12, 0, v12
    v_cvt_pk_bf16_f32 v13, 0, v13
    v_cvt_pk_bf16_f32 v14, 0, v14
    v_cvt_pk_bf16_f32 v15, 0, v15
    v_subrev_f32 v12, s45, v12
    v_subrev_f32 v13, s45, v13
    v_subrev_f32 v14, s45, v14
    v_subrev_f32 v15, s45, v15
    v_cvt_pk_bf16_f32 v12, 0, v12
    v_cvt_pk_bf16_f32 v13, 0, v13
    v_cvt_pk_bf16_f32 v14, 0, v14
    v_cvt_pk_bf16_f32 v15, 0, v15
    v_mul_f32 v12, s47, v12
    v_mul_f32 v13, s47, v13
    v_mul_f32 v14, s47, v14
    v_mul_f32 v15, s47, v15
    v_cvt_pk_bf16_f32 v45, v8, v12
    v_cvt_pk_bf16_f32 v49, v9, v13
    v_cvt_pk_bf16_f32 v53, v10, v14
    v_cvt_pk_bf16_f32 v57, v11, v15
    v_readlane_b32 s48, v3, s43
    v_readlane_b32 s49, v4, s43
    s_add_u32 s43, s43, 1
    s_nop 0
    s_lshl_b32 s44, s48, 16
    s_and_b32 s45, s48, 0xffff0000
    s_lshl_b32 s46, s49, 16
    s_and_b32 s47, s49, 0xffff0000
    s_waitcnt vmcnt(2)
    buffer_load_dwordx4 v[92:95], v1, s[28:31], s51 offen offset:3072 nt
    s_add_u32 s51, s51, 32768
    v_cvt_f32_i32 v8, v80
    v_cvt_f32_i32 v9, v81
    v_cvt_f32_i32 v10, v82
    v_cvt_f32_i32 v11, v83
    v_cvt_pk_bf16_f32 v8, 0, v8
    v_cvt_pk_bf16_f32 v9, 0, v9
    v_cvt_pk_bf16_f32 v10, 0, v10
    v_cvt_pk_bf16_f32 v11, 0, v11
    v_subrev_f32 v8, s44, v8
    v_subrev_f32 v9, s44, v9
    v_subrev_f32 v10, s44, v10
    v_subrev_f32 v11, s44, v11
    v_cvt_pk_bf16_f32 v8, 0, v8
    v_cvt_pk_bf16_f32 v9, 0, v9
    v_cvt_pk_bf16_f32 v10, 0, v10
    v_cvt_pk_bf16_f32 v11, 0, v11
    v_mul_f32 v8, s46, v8
    v_mul_f32 v9, s46, v9
    v_mul_f32 v10, s46, v10
    v_mul_f32 v11, s46, v11
    s_waitcnt vmcnt(2)
    buffer_load_dwordx4 v[80:83], v1, s[28:31], s51 offen offset:0 nt
    v_cvt_f32_i32 v12, v84
    v_cvt_f32_i32 v13, v85
    v_cvt_f32_i32 v14, v86
    v_cvt_f32_i32 v15, v87
    v_cvt_pk_bf16_f32 v12, 0, v12
    v_cvt_pk_bf16_f32 v13, 0, v13
    v_cvt_pk_bf16_f32 v14, 0, v14
    v_cvt_pk_bf16_f32 v15, 0, v15
    v_subrev_f32 v12, s45, v12
    v_subrev_f32 v13, s45, v13
    v_subrev_f32 v14, s45, v14
    v_subrev_f32 v15, s45, v15
    v_cvt_pk_bf16_f32 v12, 0, v12
    v_cvt_pk_bf16_f32 v13, 0, v13
    v_cvt_pk_bf16_f32 v14, 0, v14
    v_cvt_pk_bf16_f32 v15, 0, v15
    v_mul_f32 v12, s47, v12
    v_mul_f32 v13, s47, v13
    v_mul_f32 v14, s47, v14
    v_mul_f32 v15, s47, v15
    v_cvt_pk_bf16_f32 v46, v8, v12
    v_cvt_pk_bf16_f32 v50, v9, v13
    v_cvt_pk_bf16_f32 v54, v10, v14
    v_cvt_pk_bf16_f32 v58, v11, v15
    v_readlane_b32 s48, v3, s43
    v_readlane_b32 s49, v4, s43
    s_add_u32 s43, s43, 1
    s_nop 0
    s_lshl_b32 s44, s48, 16
    s_and_b32 s45, s48, 0xffff0000
    s_lshl_b32 s46, s49, 16
    s_and_b32 s47, s49, 0xffff0000
    s_waitcnt vmcnt(2)
    buffer_load_dwordx4 v[84:87], v1, s[28:31], s51 offen offset:1024 nt
    v_cvt_f32_i32 v8, v88
    v_cvt_f32_i32 v9, v89
    v_cvt_f32_i32 v10, v90
    v_cvt_f32_i32 v11, v91
    v_cvt_pk_bf16_f32 v8, 0, v8
    v_cvt_pk_bf16_f32 v9, 0, v9
    v_cvt_pk_bf16_f32 v10, 0, v10
    v_cvt_pk_bf16_f32 v11, 0, v11
    v_subrev_f32 v8, s44, v8
    v_subrev_f32 v9, s44, v9
    v_subrev_f32 v10, s44, v10
    v_subrev_f32 v11, s44, v11
    v_cvt_pk_bf16_f32 v8, 0, v8
    v_cvt_pk_bf16_f32 v9, 0, v9
    v_cvt_pk_bf16_f32 v10, 0, v10
    v_cvt_pk_bf16_f32 v11, 0, v11
    v_mul_f32 v8, s46, v8
    v_mul_f32 v9, s46, v9
    v_mul_f32 v10, s46, v10
    v_mul_f32 v11, s46, v11
    s_waitcnt vmcnt(2)
    buffer_load_dwordx4 v[88:91], v1, s[28:31], s51 offen offset:2048 nt
    v_cvt_f32_i32 v12, v92
    v_cvt_f32_i32 v13, v93
    v_cvt_f32_i32 v14, v94
    v_cvt_f32_i32 v15, v95
    v_cvt_pk_bf16_f32 v12, 0, v12
    v_cvt_pk_bf16_f32 v13, 0, v13
    v_cvt_pk_bf16_f32 v14, 0, v14
    v_cvt_pk_bf16_f32 v15, 0, v15
    v_subrev_f32 v12, s45, v12
    v_subrev_f32 v13, s45, v13
    v_subrev_f32 v14, s45, v14
    v_subrev_f32 v15, s45, v15
    v_cvt_pk_bf16_f32 v12, 0, v12
    v_cvt_pk_bf16_f32 v13, 0, v13
    v_cvt_pk_bf16_f32 v14, 0, v14
    v_cvt_pk_bf16_f32 v15, 0, v15
    v_mul_f32 v12, s47, v12
    v_mul_f32 v13, s47, v13
    v_mul_f32 v14, s47, v14
    v_mul_f32 v15, s47, v15
    v_cvt_pk_bf16_f32 v47, v8, v12
    v_cvt_pk_bf16_f32 v51, v9, v13
    v_cvt_pk_bf16_f32 v55, v10, v14
    v_cvt_pk_bf16_f32 v59, v11, v15
    s_waitcnt lgkmcnt(0)
    v_mfma_f32_16x16x32_bf16 v[60:63], v[40:43], v[44:47], v[60:63]
    v_mfma_f32_16x16x32_bf16 v[64:67], v[40:43], v[48:51], v[64:67]
    v_mfma_f32_16x16x32_bf16 v[68:71], v[40:43], v[52:55], v[68:71]
    v_mfma_f32_16x16x32_bf16 v[72:75], v[40:43], v[56:59], v[72:75]
    v_add_u32 v6, 32, v6
    s_sub_u32 s42, s42, 1
    s_cmp_lg_u32 s42, 0
    s_nop 3
    s_cbranch_scc1 L_vloop
    ds_read_b128 v[40:43], v6 offset:0
    v_readlane_b32 s48, v3, s43
    v_readlane_b32 s49, v4, s43
    s_add_u32 s43, s43, 1
    s_nop 0
    s_lshl_b32 s44, s48, 16
    s_and_b32 s45, s48, 0xffff0000
    s_lshl_b32 s46, s49, 16
    s_and_b32 s47, s49, 0xffff0000
    s_waitcnt vmcnt(2)
    buffer_load_dwordx4 v[92:95], v1, s[28:31], s51 offen offset:3072 nt
    s_add_u32 s51, s51, 32768
    v_cvt_f32_i32 v8, v80
    v_cvt_f32_i32 v9, v81
    v_cvt_f32_i32 v10, v82
    v_cvt_f32_i32 v11, v83
    v_cvt_pk_bf16_f32 v8, 0, v8
    v_cvt_pk_bf16_f32 v9, 0, v9
    v_cvt_pk_bf16_f32 v10, 0, v10
    v_cvt_pk_bf16_f32 v11, 0, v11
    v_subrev_f32 v8, s44, v8
    v_subrev_f32 v9, s44, v9
    v_subrev_f32 v10, s44, v10
    v_subrev_f32 v11, s44, v11
    v_cvt_pk_bf16_f32 v8, 0, v8
    v_cvt_pk_bf16_f32 v9, 0, v9
    v_cvt_pk_bf16_f32 v10, 0, v10
    v_cvt_pk_bf16_f32 v11, 0, v11
    v_mul_f32 v8, s46, v8
    v_mul_f32 v9, s46, v9
    v_mul_f32 v10, s46, v10
    v_mul_f32 v11, s46, v11
    s_waitcnt vmcnt(2)
    buffer_load_dwordx4 v[80:83], v1, s[28:31], s51 offen offset:0 nt
    v_cvt_f32_i32 v12, v84
    v_cvt_f32_i32 v13, v85
    v_cvt_f32_i32 v14, v86
    v_cvt_f32_i32 v15, v87
    v_cvt_pk_bf16_f32 v12, 0, v12
    v_cvt_pk_bf16_f32 v13, 0, v13
    v_cvt_pk_bf16_f32 v14, 0, v14
    v_cvt_pk_bf16_f32 v15, 0, v15
    v_subrev_f32 v12, s45, v12
    v_subrev_f32 v13, s45, v13
    v_subrev_f32 v14, s45, v14
    v_subrev_f32 v15, s45, v15
    v_cvt_pk_bf16_f32 v12, 0, v12
    v_cvt_pk_bf16_f32 v13, 0, v13
    v_cvt_pk_bf16_f32 v14, 0, v14
    v_cvt_pk_bf16_f32 v15, 0, v15
    v_mul_f32 v12, s47, v12
    v_mul_f32 v13, s47, v13
    v_mul_f32 v14, s47, v14
    v_mul_f32 v15, s47, v15
    v_cvt_pk_bf16_f32 v44, v8, v12
    v_cvt_pk_bf16_f32 v48, v9, v13
    v_cvt_pk_bf16_f32 v52, v10, v14
    v_cvt_pk_bf16_f32 v56, v11, v15
    v_readlane_b32 s48, v3, s43
    v_readlane_b32 s49, v4, s43
    s_add_u32 s43, s43, 1
    s_nop 0
    s_lshl_b32 s44, s48, 16
    s_and_b32 s45, s48, 0xffff0000
    s_lshl_b32 s46, s49, 16
    s_and_b32 s47, s49, 0xffff0000
    s_waitcnt vmcnt(2)
    buffer_load_dwordx4 v[84:87], v1, s[28:31], s51 offen offset:1024 nt
    v_cvt_f32_i32 v8, v88
    v_cvt_f32_i32 v9, v89
    v_cvt_f32_i32 v10, v90
    v_cvt_f32_i32 v11, v91
    v_cvt_pk_bf16_f32 v8, 0, v8
    v_cvt_pk_bf16_f32 v9, 0, v9
    v_cvt_pk_bf16_f32 v10, 0, v10
    v_cvt_pk_bf16_f32 v11, 0, v11
    v_subrev_f32 v8, s44, v8
    v_subrev_f32 v9, s44, v9
    v_subrev_f32 v10, s44, v10
    v_subrev_f32 v11, s44, v11
    v_cvt_pk_bf16_f32 v8, 0, v8
    v_cvt_pk_bf16_f32 v9, 0, v9
    v_cvt_pk_bf16_f32 v10, 0, v10
    v_cvt_pk_bf16_f32 v11, 0, v11
    v_mul_f32 v8, s46, v8
    v_mul_f32 v9, s46, v9
    v_mul_f32 v10, s46, v10
    v_mul_f32 v11, s46, v11
    s_waitcnt vmcnt(2)
    buffer_load_dwordx4 v[88:91], v1, s[28:31], s51 offen offset:2048 nt
    v_cvt_f32_i32 v12, v92
    v_cvt_f32_i32 v13, v93
    v_cvt_f32_i32 v14, v94
    v_cvt_f32_i32 v15, v95
    v_cvt_pk_bf16_f32 v12, 0, v12
    v_cvt_pk_bf16_f32 v13, 0, v13
    v_cvt_pk_bf16_f32 v14, 0, v14
    v_cvt_pk_bf16_f32 v15, 0, v15
    v_subrev_f32 v12, s45, v12
    v_subrev_f32 v13, s45, v13
    v_subrev_f32 v14, s45, v14
    v_subrev_f32 v15, s45, v15
    v_cvt_pk_bf16_f32 v12, 0, v12
    v_cvt_pk_bf16_f32 v13, 0, v13
    v_cvt_pk_bf16_f32 v14, 0, v14
    v_cvt_pk_bf16_f32 v15, 0, v15
    v_mul_f32 v12, s47, v12
    v_mul_f32 v13, s47, v13
    v_mul_f32 v14, s47, v14
    v_mul_f32 v15, s47, v15
    v_cvt_pk_bf16_f32 v45, v8, v12
    v_cvt_pk_bf16_f32 v49, v9, v13
    v_cvt_pk_bf16_f32 v53, v10, v14
    v_cvt_pk_bf16_f32 v57, v11, v15
    v_readlane_b32 s48, v3, s43
    v_readlane_b32 s49, v4, s43
    s_add_u32 s43, s43, 1
    s_nop 0
    s_lshl_b32 s44, s48, 16
    s_and_b32 s45, s48, 0xffff0000
    s_lshl_b32 s46, s49, 16
    s_and_b32 s47, s49, 0xffff0000
    s_waitcnt vmcnt(2)
    buffer_load_dwordx4 v[92:95], v1, s[28:31], s51 offen offset:3072 nt
    s_add_u32 s51, s51, 32768
    v_cvt_f32_i32 v8, v80
    v_cvt_f32_i32 v9, v81
    v_cvt_f32_i32 v10, v82
    v_cvt_f32_i32 v11, v83
    v_cvt_pk_bf16_f32 v8, 0, v8
    v_cvt_pk_bf16_f32 v9, 0, v9
    v_cvt_pk_bf16_f32 v10, 0, v10
    v_cvt_pk_bf16_f32 v11, 0, v11
    v_subrev_f32 v8, s44, v8
    v_subrev_f32 v9, s44, v9
    v_subrev_f32 v10, s44, v10
    v_subrev_f32 v11, s44, v11
    v_cvt_pk_bf16_f32 v8, 0, v8
    v_cvt_pk_bf16_f32 v9, 0, v9
    v_cvt_pk_bf16_f32 v10, 0, v10
    v_cvt_pk_bf16_f32 v11, 0, v11
    v_mul_f32 v8, s46, v8
    v_mul_f32 v9, s46, v9
    v_mul_f32 v10, s46, v10
    v_mul_f32 v11, s46, v11
    s_waitcnt vmcnt(2)
    buffer_load_dwordx4 v[80:83], v1, s[28:31], s51 offen offset:0 nt
    v_cvt_f32_i32 v12, v84
    v_cvt_f32_i32 v13, v85
    v_cvt_f32_i32 v14, v86
    v_cvt_f32_i32 v15, v87
    v_cvt_pk_bf16_f32 v12, 0, v12
    v_cvt_pk_bf16_f32 v13, 0, v13
    v_cvt_pk_bf16_f32 v14, 0, v14
    v_cvt_pk_bf16_f32 v15, 0, v15
    v_subrev_f32 v12, s45, v12
    v_subrev_f32 v13, s45, v13
    v_subrev_f32 v14, s45, v14
    v_subrev_f32 v15, s45, v15
    v_cvt_pk_bf16_f32 v12, 0, v12
    v_cvt_pk_bf16_f32 v13, 0, v13
    v_cvt_pk_bf16_f32 v14, 0, v14
    v_cvt_pk_bf16_f32 v15, 0, v15
    v_mul_f32 v12, s47, v12
    v_mul_f32 v13, s47, v13
    v_mul_f32 v14, s47, v14
    v_mul_f32 v15, s47, v15
    v_cvt_pk_bf16_f32 v46, v8, v12
    v_cvt_pk_bf16_f32 v50, v9, v13
    v_cvt_pk_bf16_f32 v54, v10, v14
    v_cvt_pk_bf16_f32 v58, v11, v15
    v_readlane_b32 s48, v3, s43
    v_readlane_b32 s49, v4, s43
    s_add_u32 s43, s43, 1
    s_nop 0
    s_lshl_b32 s44, s48, 16
    s_and_b32 s45, s48, 0xffff0000
    s_lshl_b32 s46, s49, 16
    s_and_b32 s47, s49, 0xffff0000
    s_waitcnt vmcnt(2)
    buffer_load_dwordx4 v[84:87], v1, s[28:31], s51 offen offset:1024 nt
    v_cvt_f32_i32 v8, v88
    v_cvt_f32_i32 v9, v89
    v_cvt_f32_i32 v10, v90
    v_cvt_f32_i32 v11, v91
    v_cvt_pk_bf16_f32 v8, 0, v8
    v_cvt_pk_bf16_f32 v9, 0, v9
    v_cvt_pk_bf16_f32 v10, 0, v10
    v_cvt_pk_bf16_f32 v11, 0, v11
    v_subrev_f32 v8, s44, v8
    v_subrev_f32 v9, s44, v9
    v_subrev_f32 v10, s44, v10
    v_subrev_f32 v11, s44, v11
    v_cvt_pk_bf16_f32 v8, 0, v8
    v_cvt_pk_bf16_f32 v9, 0, v9
    v_cvt_pk_bf16_f32 v10, 0, v10
    v_cvt_pk_bf16_f32 v11, 0, v11
    v_mul_f32 v8, s46, v8
    v_mul_f32 v9, s46, v9
    v_mul_f32 v10, s46, v10
    v_mul_f32 v11, s46, v11
    s_waitcnt vmcnt(2)
    buffer_load_dwordx4 v[88:91], v1, s[28:31], s51 offen offset:2048 nt
    v_cvt_f32_i32 v12, v92
    v_cvt_f32_i32 v13, v93
    v_cvt_f32_i32 v14, v94
    v_cvt_f32_i32 v15, v95
    v_cvt_pk_bf16_f32 v12, 0, v12
    v_cvt_pk_bf16_f32 v13, 0, v13
    v_cvt_pk_bf16_f32 v14, 0, v14
    v_cvt_pk_bf16_f32 v15, 0, v15
    v_subrev_f32 v12, s45, v12
    v_subrev_f32 v13, s45, v13
    v_subrev_f32 v14, s45, v14
    v_subrev_f32 v15, s45, v15
    v_cvt_pk_bf16_f32 v12, 0, v12
    v_cvt_pk_bf16_f32 v13, 0, v13
    v_cvt_pk_bf16_f32 v14, 0, v14
    v_cvt_pk_bf16_f32 v15, 0, v15
    v_mul_f32 v12, s47, v12
    v_mul_f32 v13, s47, v13
    v_mul_f32 v14, s47, v14
    v_mul_f32 v15, s47, v15
    v_cvt_pk_bf16_f32 v47, v8, v12
    v_cvt_pk_bf16_f32 v51, v9, v13
    v_cvt_pk_bf16_f32 v55, v10, v14
    v_cvt_pk_bf16_f32 v59, v11, v15
    s_waitcnt lgkmcnt(0)
    v_mfma_f32_16x16x32_bf16 v[60:63], v[40:43], v[44:47], v[60:63]
    v_mfma_f32_16x16x32_bf16 v[64:67], v[40:43], v[48:51], v[64:67]
    v_mfma_f32_16x16x32_bf16 v[68:71], v[40:43], v[52:55], v[68:71]
    v_mfma_f32_16x16x32_bf16 v[72:75], v[40:43], v[56:59], v[72:75]
    ds_read_b128 v[40:43], v6 offset:16
    v_readlane_b32 s48, v3, s43
    v_readlane_b32 s49, v4, s43
    s_add_u32 s43, s43, 1
    s_nop 0
    s_lshl_b32 s44, s48, 16
    s_and_b32 s45, s48, 0xffff0000
    s_lshl_b32 s46, s49, 16
    s_and_b32 s47, s49, 0xffff0000
    s_waitcnt vmcnt(2)
    buffer_load_dwordx4 v[92:95], v1, s[28:31], s51 offen offset:3072 nt
    s_add_u32 s51, s51, 32768
    v_cvt_f32_i32 v8, v80
    v_cvt_f32_i32 v9, v81
    v_cvt_f32_i32 v10, v82
    v_cvt_f32_i32 v11, v83
    v_cvt_pk_bf16_f32 v8, 0, v8
    v_cvt_pk_bf16_f32 v9, 0, v9
    v_cvt_pk_bf16_f32 v10, 0, v10
    v_cvt_pk_bf16_f32 v11, 0, v11
    v_subrev_f32 v8, s44, v8
    v_subrev_f32 v9, s44, v9
    v_subrev_f32 v10, s44, v10
    v_subrev_f32 v11, s44, v11
    v_cvt_pk_bf16_f32 v8, 0, v8
    v_cvt_pk_bf16_f32 v9, 0, v9
    v_cvt_pk_bf16_f32 v10, 0, v10
    v_cvt_pk_bf16_f32 v11, 0, v11
    v_mul_f32 v8, s46, v8
    v_mul_f32 v9, s46, v9
    v_mul_f32 v10, s46, v10
    v_mul_f32 v11, s46, v11
    s_waitcnt vmcnt(2)
    buffer_load_dwordx4 v[80:83], v1, s[28:31], s51 offen offset:0 nt
    v_cvt_f32_i32 v12, v84
    v_cvt_f32_i32 v13, v85
    v_cvt_f32_i32 v14, v86
    v_cvt_f32_i32 v15, v87
    v_cvt_pk_bf16_f32 v12, 0, v12
    v_cvt_pk_bf16_f32 v13, 0, v13
    v_cvt_pk_bf16_f32 v14, 0, v14
    v_cvt_pk_bf16_f32 v15, 0, v15
    v_subrev_f32 v12, s45, v12
    v_subrev_f32 v13, s45, v13
    v_subrev_f32 v14, s45, v14
    v_subrev_f32 v15, s45, v15
    v_cvt_pk_bf16_f32 v12, 0, v12
    v_cvt_pk_bf16_f32 v13, 0, v13
    v_cvt_pk_bf16_f32 v14, 0, v14
    v_cvt_pk_bf16_f32 v15, 0, v15
    v_mul_f32 v12, s47, v12
    v_mul_f32 v13, s47, v13
    v_mul_f32 v14, s47, v14
    v_mul_f32 v15, s47, v15
    v_cvt_pk_bf16_f32 v44, v8, v12
    v_cvt_pk_bf16_f32 v48, v9, v13
    v_cvt_pk_bf16_f32 v52, v10, v14
    v_cvt_pk_bf16_f32 v56, v11, v15
    v_readlane_b32 s48, v3, s43
    v_readlane_b32 s49, v4, s43
    s_add_u32 s43, s43, 1
    s_nop 0
    s_lshl_b32 s44, s48, 16
    s_and_b32 s45, s48, 0xffff0000
    s_lshl_b32 s46, s49, 16
    s_and_b32 s47, s49, 0xffff0000
    s_waitcnt vmcnt(2)
    buffer_load_dwordx4 v[84:87], v1, s[28:31], s51 offen offset:1024 nt
    v_cvt_f32_i32 v8, v88
    v_cvt_f32_i32 v9, v89
    v_cvt_f32_i32 v10, v90
    v_cvt_f32_i32 v11, v91
    v_cvt_pk_bf16_f32 v8, 0, v8
    v_cvt_pk_bf16_f32 v9, 0, v9
    v_cvt_pk_bf16_f32 v10, 0, v10
    v_cvt_pk_bf16_f32 v11, 0, v11
    v_subrev_f32 v8, s44, v8
    v_subrev_f32 v9, s44, v9
    v_subrev_f32 v10, s44, v10
    v_subrev_f32 v11, s44, v11
    v_cvt_pk_bf16_f32 v8, 0, v8
    v_cvt_pk_bf16_f32 v9, 0, v9
    v_cvt_pk_bf16_f32 v10, 0, v10
    v_cvt_pk_bf16_f32 v11, 0, v11
    v_mul_f32 v8, s46, v8
    v_mul_f32 v9, s46, v9
    v_mul_f32 v10, s46, v10
    v_mul_f32 v11, s46, v11
    s_waitcnt vmcnt(2)
    buffer_load_dwordx4 v[88:91], v1, s[28:31], s51 offen offset:2048 nt
    v_cvt_f32_i32 v12, v92
    v_cvt_f32_i32 v13, v93
    v_cvt_f32_i32 v14, v94
    v_cvt_f32_i32 v15, v95
    v_cvt_pk_bf16_f32 v12, 0, v12
    v_cvt_pk_bf16_f32 v13, 0, v13
    v_cvt_pk_bf16_f32 v14, 0, v14
    v_cvt_pk_bf16_f32 v15, 0, v15
    v_subrev_f32 v12, s45, v12
    v_subrev_f32 v13, s45, v13
    v_subrev_f32 v14, s45, v14
    v_subrev_f32 v15, s45, v15
    v_cvt_pk_bf16_f32 v12, 0, v12
    v_cvt_pk_bf16_f32 v13, 0, v13
    v_cvt_pk_bf16_f32 v14, 0, v14
    v_cvt_pk_bf16_f32 v15, 0, v15
    v_mul_f32 v12, s47, v12
    v_mul_f32 v13, s47, v13
    v_mul_f32 v14, s47, v14
    v_mul_f32 v15, s47, v15
    v_cvt_pk_bf16_f32 v45, v8, v12
    v_cvt_pk_bf16_f32 v49, v9, v13
    v_cvt_pk_bf16_f32 v53, v10, v14
    v_cvt_pk_bf16_f32 v57, v11, v15
    v_readlane_b32 s48, v3, s43
    v_readlane_b32 s49, v4, s43
    s_add_u32 s43, s43, 1
    s_nop 0
    s_lshl_b32 s44, s48, 16
    s_and_b32 s45, s48, 0xffff0000
    s_lshl_b32 s46, s49, 16
    s_and_b32 s47, s49, 0xffff0000
    s_waitcnt vmcnt(2)
    buffer_load_dwordx4 v[92:95], v1, s[28:31], s51 offen offset:3072 nt
    s_add_u32 s51, s51, 32768
    v_cvt_f32_i32 v8, v80
    v_cvt_f32_i32 v9, v81
    v_cvt_f32_i32 v10, v82
    v_cvt_f32_i32 v11, v83
    v_cvt_pk_bf16_f32 v8, 0, v8
    v_cvt_pk_bf16_f32 v9, 0, v9
    v_cvt_pk_bf16_f32 v10, 0, v10
    v_cvt_pk_bf16_f32 v11, 0, v11
    v_subrev_f32 v8, s44, v8
    v_subrev_f32 v9, s44, v9
    v_subrev_f32 v10, s44, v10
    v_subrev_f32 v11, s44, v11
    v_cvt_pk_bf16_f32 v8, 0, v8
    v_cvt_pk_bf16_f32 v9, 0, v9
    v_cvt_pk_bf16_f32 v10, 0, v10
    v_cvt_pk_bf16_f32 v11, 0, v11
    v_mul_f32 v8, s46, v8
    v_mul_f32 v9, s46, v9
    v_mul_f32 v10, s46, v10
    v_mul_f32 v11, s46, v11
    s_waitcnt vmcnt(2)
    v_cvt_f32_i32 v12, v84
    v_cvt_f32_i32 v13, v85
    v_cvt_f32_i32 v14, v86
    v_cvt_f32_i32 v15, v87
    v_cvt_pk_bf16_f32 v12, 0, v12
    v_cvt_pk_bf16_f32 v13, 0, v13
    v_cvt_pk_bf16_f32 v14, 0, v14
    v_cvt_pk_bf16_f32 v15, 0, v15
    v_subrev_f32 v12, s45, v12
    v_subrev_f32 v13, s45, v13
    v_subrev_f32 v14, s45, v14
    v_subrev_f32 v15, s45, v15
    v_cvt_pk_bf16_f32 v12, 0, v12
    v_cvt_pk_bf16_f32 v13, 0, v13
    v_cvt_pk_bf16_f32 v14, 0, v14
    v_cvt_pk_bf16_f32 v15, 0, v15
    v_mul_f32 v12, s47, v12
    v_mul_f32 v13, s47, v13
    v_mul_f32 v14, s47, v14
    v_mul_f32 v15, s47, v15
    v_cvt_pk_bf16_f32 v46, v8, v12
    v_cvt_pk_bf16_f32 v50, v9, v13
    v_cvt_pk_bf16_f32 v54, v10, v14
    v_cvt_pk_bf16_f32 v58, v11, v15
    v_readlane_b32 s48, v3, s43
    v_readlane_b32 s49, v4, s43
    s_add_u32 s43, s43, 1
    s_nop 0
    s_lshl_b32 s44, s48, 16
    s_and_b32 s45, s48, 0xffff0000
    s_lshl_b32 s46, s49, 16
    s_and_b32 s47, s49, 0xffff0000
    s_waitcnt vmcnt(1)
    v_cvt_f32_i32 v8, v88
    v_cvt_f32_i32 v9, v89
    v_cvt_f32_i32 v10, v90
    v_cvt_f32_i32 v11, v91
    v_cvt_pk_bf16_f32 v8, 0, v8
    v_cvt_pk_bf16_f32 v9, 0, v9
    v_cvt_pk_bf16_f32 v10, 0, v10
    v_cvt_pk_bf16_f32 v11, 0, v11
    v_subrev_f32 v8, s44, v8
    v_subrev_f32 v9, s44, v9
    v_subrev_f32 v10, s44, v10
    v_subrev_f32 v11, s44, v11
    v_cvt_pk_bf16_f32 v8, 0, v8
    v_cvt_pk_bf16_f32 v9, 0, v9
    v_cvt_pk_bf16_f32 v10, 0, v10
    v_cvt_pk_bf16_f32 v11, 0, v11
    v_mul_f32 v8, s46, v8
    v_mul_f32 v9, s46, v9
    v_mul_f32 v10, s46, v10
    v_mul_f32 v11, s46, v11
    s_waitcnt vmcnt(0)
    v_cvt_f32_i32 v12, v92
    v_cvt_f32_i32 v13, v93
    v_cvt_f32_i32 v14, v94
    v_cvt_f32_i32 v15, v95
    v_cvt_pk_bf16_f32 v12, 0, v12
    v_cvt_pk_bf16_f32 v13, 0, v13
    v_cvt_pk_bf16_f32 v14, 0, v14
    v_cvt_pk_bf16_f32 v15, 0, v15
    v_subrev_f32 v12, s45, v12
    v_subrev_f32 v13, s45, v13
    v_subrev_f32 v14, s45, v14
    v_subrev_f32 v15, s45, v15
    v_cvt_pk_bf16_f32 v12, 0, v12
    v_cvt_pk_bf16_f32 v13, 0, v13
    v_cvt_pk_bf16_f32 v14, 0, v14
    v_cvt_pk_bf16_f32 v15, 0, v15
    v_mul_f32 v12, s47, v12
    v_mul_f32 v13, s47, v13
    v_mul_f32 v14, s47, v14
    v_mul_f32 v15, s47, v15
    v_cvt_pk_bf16_f32 v47, v8, v12
    v_cvt_pk_bf16_f32 v51, v9, v13
    v_cvt_pk_bf16_f32 v55, v10, v14
    v_cvt_pk_bf16_f32 v59, v11, v15
    s_waitcnt lgkmcnt(0)
    v_mfma_f32_16x16x32_bf16 v[60:63], v[40:43], v[44:47], v[60:63]
    v_mfma_f32_16x16x32_bf16 v[64:67], v[40:43], v[48:51], v[64:67]
    v_mfma_f32_16x16x32_bf16 v[68:71], v[40:43], v[52:55], v[68:71]
    v_mfma_f32_16x16x32_bf16 v[72:75], v[40:43], v[56:59], v[72:75]
    v_lshrrev_b32 v8, 4, v2
    v_lshlrev_b32 v8, 9, v8
    v_and_b32 v9, 15, v2
    v_lshl_add_u32 v8, v9, 4, v8
    v_add_u32 v8, s40, v8
    v_lshrrev_b32 v9, 5, v2
    v_lshlrev_b32 v9, 3, v9
    s_lshl_b32 s41, s38, 4
    v_add_u32 v9, s41, v9
    ds_write_b64 v9, v[36:37] offset:16384
    v_mov_b32 v44, v60
    v_mov_b32 v45, v64
    v_mov_b32 v46, v68
    v_mov_b32 v47, v72
    v_mov_b32 v48, v61
    v_mov_b32 v49, v65
    v_mov_b32 v50, v69
    v_mov_b32 v51, v73
    v_mov_b32 v52, v62
    v_mov_b32 v53, v66
    v_mov_b32 v54, v70
    v_mov_b32 v55, v74
    v_mov_b32 v56, v63
    v_mov_b32 v57, v67
    v_mov_b32 v58, v71
    v_mov_b32 v59, v75
    s_mov_b32 exec_hi, 0
    ds_write_b128 v8, v[44:47] offset:0
    ds_write_b128 v8, v[48:51] offset:1024
    ds_write_b128 v8, v[52:55] offset:256
    ds_write_b128 v8, v[56:59] offset:1280
    s_mov_b64 exec, -1
    s_waitcnt lgkmcnt(0)
    s_barrier
    s_cmp_lg_u32 s38, 0
    s_cbranch_scc1 L_part_end
    v_lshlrev_b32 v38, 5, v2
    v_lshrrev_b32 v8, 5, v2
    v_lshlrev_b32 v39, 3, v8
    ds_read_b64 v[8:9], v39 offset:16384
    ds_read_b64 v[10:11], v39 offset:16400
    ds_read_b64 v[12:13], v39 offset:16416
    ds_read_b64 v[14:15], v39 offset:16432
    ds_read_b64 v[16:17], v39 offset:16448
    ds_read_b64 v[18:19], v39 offset:16464
    ds_read_b64 v[20:21], v39 offset:16480
    ds_read_b64 v[22:23], v39 offset:16496
    ds_read_b128 v[80:83], v38 offset:0
    ds_read_b128 v[84:87], v38 offset:16
    ds_read_b128 v[88:91], v38 offset:2048
    ds_read_b128 v[92:95], v38 offset:2064
    ds_read_b128 v[96:99], v38 offset:4096
    ds_read_b128 v[100:103], v38 offset:4112
    ds_read_b128 v[104:107], v38 offset:6144
    ds_read_b128 v[108:111], v38 offset:6160
    ds_read_b128 v[112:115], v38 offset:8192
    ds_read_b128 v[116:119], v38 offset:8208
    ds_read_b128 v[120:123], v38 offset:10240
    ds_read_b128 v[124:127], v38 offset:10256
    ds_read_b128 v[128:131], v38 offset:12288
    ds_read_b128 v[132:135], v38 offset:12304
    ds_read_b128 v[136:139], v38 offset:14336
    ds_read_b128 v[140:143], v38 offset:14352
    s_waitcnt lgkmcnt(0)
    v_mov_b32 v36, v8
    v_max_f32 v36, v36, v10
    v_max_f32 v36, v36, v12
    v_max_f32 v36, v36, v14
    v_max_f32 v36, v36, v16
    v_max_f32 v36, v36, v18
    v_max_f32 v36, v36, v20
    v_max_f32 v36, v36, v22
    v_sub_f32 v8, v8, v36
    v_sub_f32 v10, v10, v36
    v_sub_f32 v12, v12, v36
    v_sub_f32 v14, v14, v36
    v_sub_f32 v16, v16, v36
    v_sub_f32 v18, v18, v36
    v_sub_f32 v20, v20, v36
    v_sub_f32 v22, v22, v36
    v_mul_f32 v8, s50, v8
    v_mul_f32 v10, s50, v10
    v_mul_f32 v12, s50, v12
    v_mul_f32 v14, s50, v14
    v_mul_f32 v16, s50, v16
    v_mul_f32 v18, s50, v18
    v_mul_f32 v20, s50, v20
    v_mul_f32 v22, s50, v22
    v_exp_f32 v8, v8
    v_exp_f32 v10, v10
    v_exp_f32 v12, v12
    v_exp_f32 v14, v14
    v_exp_f32 v16, v16
    v_exp_f32 v18, v18
    v_exp_f32 v20, v20
    v_exp_f32 v22, v22
    v_mul_f32 v37, v8, v9
    v_mul_f32 v60, v8, v80
    v_mul_f32 v61, v8, v81
    v_mul_f32 v62, v8, v82
    v_mul_f32 v63, v8, v83
    v_mul_f32 v64, v8, v84
    v_mul_f32 v65, v8, v85
    v_mul_f32 v66, v8, v86
    v_mul_f32 v67, v8, v87
    v_fmac_f32 v37, v10, v11
    v_fmac_f32 v60, v10, v88
    v_fmac_f32 v61, v10, v89
    v_fmac_f32 v62, v10, v90
    v_fmac_f32 v63, v10, v91
    v_fmac_f32 v64, v10, v92
    v_fmac_f32 v65, v10, v93
    v_fmac_f32 v66, v10, v94
    v_fmac_f32 v67, v10, v95
    v_fmac_f32 v37, v12, v13
    v_fmac_f32 v60, v12, v96
    v_fmac_f32 v61, v12, v97
    v_fmac_f32 v62, v12, v98
    v_fmac_f32 v63, v12, v99
    v_fmac_f32 v64, v12, v100
    v_fmac_f32 v65, v12, v101
    v_fmac_f32 v66, v12, v102
    v_fmac_f32 v67, v12, v103
    v_fmac_f32 v37, v14, v15
    v_fmac_f32 v60, v14, v104
    v_fmac_f32 v61, v14, v105
    v_fmac_f32 v62, v14, v106
    v_fmac_f32 v63, v14, v107
    v_fmac_f32 v64, v14, v108
    v_fmac_f32 v65, v14, v109
    v_fmac_f32 v66, v14, v110
    v_fmac_f32 v67, v14, v111
    v_fmac_f32 v37, v16, v17
    v_fmac_f32 v60, v16, v112
    v_fmac_f32 v61, v16, v113
    v_fmac_f32 v62, v16, v114
    v_fmac_f32 v63, v16, v115
    v_fmac_f32 v64, v16, v116
    v_fmac_f32 v65, v16, v117
    v_fmac_f32 v66, v16, v118
    v_fmac_f32 v67, v16, v119
    v_fmac_f32 v37, v18, v19
    v_fmac_f32 v60, v18, v120
    v_fmac_f32 v61, v18, v121
    v_fmac_f32 v62, v18, v122
    v_fmac_f32 v63, v18, v123
    v_fmac_f32 v64, v18, v124
    v_fmac_f32 v65, v18, v125
    v_fmac_f32 v66, v18, v126
    v_fmac_f32 v67, v18, v127
    v_fmac_f32 v37, v20, v21
    v_fmac_f32 v60, v20, v128
    v_fmac_f32 v61, v20, v129
    v_fmac_f32 v62, v20, v130
    v_fmac_f32 v63, v20, v131
    v_fmac_f32 v64, v20, v132
    v_fmac_f32 v65, v20, v133
    v_fmac_f32 v66, v20, v134
    v_fmac_f32 v67, v20, v135
    v_fmac_f32 v37, v22, v23
    v_fmac_f32 v60, v22, v136
    v_fmac_f32 v61, v22, v137
    v_fmac_f32 v62, v22, v138
    v_fmac_f32 v63, v22, v139
    v_fmac_f32 v64, v22, v140
    v_fmac_f32 v65, v22, v141
    v_fmac_f32 v66, v22, v142
    v_fmac_f32 v67, v22, v143
    s_lshl_b32 s41, s2, 11
    buffer_store_dwordx4 v[60:63], v38, s[52:55], s41 offen sc1
    buffer_store_dwordx4 v[64:67], v38, s[52:55], s41 offen offset:16 sc1
    s_lshl_b32 s41, s2, 4
    s_add_u32 s41, s41, 0x400000
    s_mov_b32 exec_lo, 1
    s_mov_b32 exec_hi, 1
    buffer_store_dwordx2 v[36:37], v39, s[52:55], s41 offen sc1
    s_mov_b32 s32, s20
    s_and_b32 s33, s21, 0xffff
    s_mov_b32 s34, 256
    s_mov_b32 s35, 0x00020000
    s_lshl_b32 s41, s36, 2
    v_mov_b32 v8, 1
    v_mov_b32 v9, 0
    s_mov_b32 exec_hi, 0
    s_waitcnt vmcnt(0)
    buffer_atomic_add v8, v9, s[32:35], s41 offen sc0 sc1
    s_waitcnt vmcnt(0)
    v_readfirstlane_b32 s40, v8
    s_mov_b64 exec, -1
    s_nop 1
    s_cmp_lg_u32 s40, 3
    s_cbranch_scc1 L_part_end
    s_mul_i32 s40, s36, 8192
    s_mul_i32 s41, s36, 64
    s_add_u32 s41, s41, 0x400000
    buffer_load_dwordx2 v[8:9], v39, s[52:55], s41 offen offset:0 sc1
    buffer_load_dwordx2 v[10:11], v39, s[52:55], s41 offen offset:16 sc1
    buffer_load_dwordx2 v[12:13], v39, s[52:55], s41 offen offset:32 sc1
    buffer_load_dwordx2 v[14:15], v39, s[52:55], s41 offen offset:48 sc1
    buffer_load_dwordx4 v[80:83], v38, s[52:55], s40 offen offset:0 sc1
    buffer_load_dwordx4 v[84:87], v38, s[52:55], s40 offen offset:16 sc1
    buffer_load_dwordx4 v[88:91], v38, s[52:55], s40 offen offset:2048 sc1
    buffer_load_dwordx4 v[92:95], v38, s[52:55], s40 offen offset:2064 sc1
    s_add_u32 s40, s40, 4096
    buffer_load_dwordx4 v[96:99], v38, s[52:55], s40 offen offset:0 sc1
    buffer_load_dwordx4 v[100:103], v38, s[52:55], s40 offen offset:16 sc1
    buffer_load_dwordx4 v[104:107], v38, s[52:55], s40 offen offset:2048 sc1
    buffer_load_dwordx4 v[108:111], v38, s[52:55], s40 offen offset:2064 sc1
    s_add_u32 s40, s40, 4096
    s_mov_b32 s32, s18
    s_and_b32 s33, s19, 0xffff
    s_mov_b32 s34, 65536
    s_mov_b32 s35, 0x00020000
    s_lshl_b32 s41, s36, 10
    v_lshlrev_b32 v39, 4, v2
    s_waitcnt vmcnt(0)
    v_mov_b32 v36, v8
    v_max_f32 v36, v36, v10
    v_max_f32 v36, v36, v12
    v_max_f32 v36, v36, v14
    v_sub_f32 v8, v8, v36
    v_sub_f32 v10, v10, v36
    v_sub_f32 v12, v12, v36
    v_sub_f32 v14, v14, v36
    v_mul_f32 v8, s50, v8
    v_mul_f32 v10, s50, v10
    v_mul_f32 v12, s50, v12
    v_mul_f32 v14, s50, v14
    v_exp_f32 v8, v8
    v_exp_f32 v10, v10
    v_exp_f32 v12, v12
    v_exp_f32 v14, v14
    v_mul_f32 v37, v8, v9
    v_mul_f32 v60, v8, v80
    v_mul_f32 v61, v8, v81
    v_mul_f32 v62, v8, v82
    v_mul_f32 v63, v8, v83
    v_mul_f32 v64, v8, v84
    v_mul_f32 v65, v8, v85
    v_mul_f32 v66, v8, v86
    v_mul_f32 v67, v8, v87
    v_fmac_f32 v37, v10, v11
    v_fmac_f32 v60, v10, v88
    v_fmac_f32 v61, v10, v89
    v_fmac_f32 v62, v10, v90
    v_fmac_f32 v63, v10, v91
    v_fmac_f32 v64, v10, v92
    v_fmac_f32 v65, v10, v93
    v_fmac_f32 v66, v10, v94
    v_fmac_f32 v67, v10, v95
    v_fmac_f32 v37, v12, v13
    v_fmac_f32 v60, v12, v96
    v_fmac_f32 v61, v12, v97
    v_fmac_f32 v62, v12, v98
    v_fmac_f32 v63, v12, v99
    v_fmac_f32 v64, v12, v100
    v_fmac_f32 v65, v12, v101
    v_fmac_f32 v66, v12, v102
    v_fmac_f32 v67, v12, v103
    v_fmac_f32 v37, v14, v15
    v_fmac_f32 v60, v14, v104
    v_fmac_f32 v61, v14, v105
    v_fmac_f32 v62, v14, v106
    v_fmac_f32 v63, v14, v107
    v_fmac_f32 v64, v14, v108
    v_fmac_f32 v65, v14, v109
    v_fmac_f32 v66, v14, v110
    v_fmac_f32 v67, v14, v111
    v_rcp_f32 v37, v37
    s_nop 0
    v_mul_f32 v60, v60, v37
    v_mul_f32 v61, v61, v37
    v_mul_f32 v62, v62, v37
    v_mul_f32 v63, v63, v37
    v_mul_f32 v64, v64, v37
    v_mul_f32 v65, v65, v37
    v_mul_f32 v66, v66, v37
    v_mul_f32 v67, v67, v37
    v_cvt_pk_bf16_f32 v44, v60, v61
    v_cvt_pk_bf16_f32 v45, v62, v63
    v_cvt_pk_bf16_f32 v46, v64, v65
    v_cvt_pk_bf16_f32 v47, v66, v67
    buffer_store_dwordx4 v[44:47], v39, s[32:35], s41 offen
L_part_end:
    s_endpgm
.section .rodata,"a"
.p2align 6
.amdhsa_kernel standalone__kv_cache_quant_int4_int2_kv_with_per_channel_or_per_token_scales__decode_kernel
  .amdhsa_next_free_vgpr 144
  .amdhsa_next_free_sgpr 72
  .amdhsa_accum_offset 144
  .amdhsa_group_segment_fixed_size 0
  .amdhsa_kernarg_size 80
  .amdhsa_user_sgpr_count 2
  .amdhsa_user_sgpr_kernarg_segment_ptr 1
  .amdhsa_system_sgpr_workgroup_id_x 1
  .amdhsa_float_denorm_mode_32 3
.end_amdhsa_kernel
```
